```python
import torch

def _softmax(x, axis=-1):
    return torch.softmax(x, dim=axis)
def _gelu(x):
    return torch.nn.functional.gelu(x, approximate="tanh")
def _silu(x):
    return torch.nn.functional.silu(x)
def _sigmoid(x):
    return torch.sigmoid(x)
def _layernorm(x, axis=-1, eps=1e-5):
    m = x.mean(dim=axis, keepdim=True)
    v = x.var(dim=axis, keepdim=True, unbiased=False)
    return (x - m) / torch.sqrt(v + eps)
def _scatter_add(tgt, idx, src, axis=0):
    return tgt.clone().index_add_(axis, idx, src)
def _segment_sum(src, seg, n):
    out = torch.zeros((n,) + src.shape[1:], dtype=src.dtype)
    return out.index_add_(0, seg, src)
def _pad(x, pw):
    flat = tuple(v for pair in reversed(pw) for v in pair)
    return torch.nn.functional.pad(x, flat)

kernel_name = 'gated_mix__ssm_conv_s4d__mha_block__prompt'

def setup_inputs():

    _w = (lambda a: (lambda t: t.to(torch.bfloat16) if t.is_floating_point() else t)(torch.as_tensor(a)))
    def _A_setup():
        Bsz, L, D, N = 1, 2048, 576, 128
        return {
            "u": _w((lambda *s: torch.randn(*s, dtype=torch.bfloat16) * 0.05)(Bsz, L, D)),
            "log_A_real": _w((lambda *s: torch.randn(*s, dtype=torch.bfloat16) * 6.4)(D, N) * 0.5),
            "A_imag": _w((lambda *s: torch.randn(*s, dtype=torch.bfloat16) * 0.1)(D, N) * 3.14),
            "C_real": _w((lambda *s: torch.randn(*s, dtype=torch.bfloat16) * 0.4)(D, N) / N ** 0.5),
            "C_imag": _w((lambda *s: torch.randn(*s, dtype=torch.bfloat16) * 0.4)(D, N) / N ** 0.5),
            "log_dt": _w((lambda *s: torch.randn(*s, dtype=torch.bfloat16) * 0.1)(D) * 0.5 - 4.0),
            "D_skip": _w((lambda *s: torch.randn(*s, dtype=torch.bfloat16) * 0.1)(D)),
        }
    _A_in = _A_setup()

    def _B_setup():
        B, S, D, H = 1, 2048, 576, 32
        return {
            "x": _w((lambda *s: torch.randn(*s, dtype=torch.bfloat16) * 0.05)(B, S, D)),
            "wqkv": _w((lambda *s: torch.randn(*s, dtype=torch.bfloat16) * 0.8)(D, 3 * D)),
            "wo": _w((lambda *s: torch.randn(*s, dtype=torch.bfloat16) * 0.05)(D, D)),
        }
    _B_in = _B_setup()

    return {
        "A_u": _A_in["u"],
        "A_log_A_real": _A_in["log_A_real"],
        "A_A_imag": _A_in["A_imag"],
        "A_C_real": _A_in["C_real"],
        "A_C_imag": _A_in["C_imag"],
        "A_log_dt": _A_in["log_dt"],
        "A_D_skip": _A_in["D_skip"],
        "B_x": _B_in["x"],
        "B_wqkv": _B_in["wqkv"],
        "B_wo": _B_in["wo"],
        "gate_w": _w((lambda *s: torch.randn(*s, dtype=torch.bfloat16) * 0.05)(576) * 16.0),
    }

def reference(A_u, A_log_A_real, A_A_imag, A_C_real, A_C_imag, A_log_dt, A_D_skip, B_x, B_wqkv, B_wo, gate_w):
    def _A_ref(u, log_A_real, A_imag, C_real, C_imag, log_dt, D_skip):
        L = u.shape[1]
        dt = torch.exp(log_dt)
        A = -torch.exp(log_A_real) + 1j * A_imag
        C = (C_real + 1j * C_imag) * dt[:, None]
        pos = (lambda x, dt: x.to(dt))(torch.arange(L), log_dt.dtype)
        P = torch.exp((A * dt[:, None])[:, :, None] * pos[None, None, :])
        K = 2.0 * torch.einsum("dn,dnl->dl", C, P).real
        L2 = 2 * L
        u_t = (lambda x, *d: x.permute(*d))(u, 0, 2, 1)
        Kf = (lambda x, *a, **k: torch.fft.rfft(x.float(), *a, **k))(K, L2)
        Uf = (lambda x, *a, **k: torch.fft.rfft(x.float(), *a, **k))(u_t, L2)
        y = (lambda x, *a, **k: torch.fft.irfft(x, *a, **k).to(torch.bfloat16))(Uf * Kf[None, :, :], L2)[:, :, :L]
        y = (lambda x, *d: x.permute(*d))(y, 0, 2, 1)
        return y + u * D_skip[None, None, :]

    def _B_ref(x, wqkv, wo):
        B, S, D = x.shape
        H = 32
        Dh = D // H
        qkv = (lambda x, *d: x.permute(*d))((x @ wqkv).reshape(B, S, 3, H, Dh), 2, 0, 3, 1, 4)
        q, k, v = qkv[0], qkv[1], qkv[2]
        scores = torch.einsum("bhqd,bhkd->bhqk", q, k) * (Dh ** -0.5)
        p = _softmax(scores, axis=-1)
        o = torch.einsum("bhqk,bhkd->bhqd", p, v)
        return (lambda x, *d: x.permute(*d))(o, 0, 2, 1, 3).reshape(B, S, D) @ wo

    x = A_u
    g = _sigmoid((x * gate_w).sum(-1, keepdims=True))
    a = _A_ref(x, A_log_A_real, A_A_imag, A_C_real, A_C_imag, A_log_dt, A_D_skip)
    b = _B_ref(x, B_wqkv, B_wo)
    return g * a + (1 - g) * b
```

```asm
; @launch grid=(256,1,1) block=(1024,1,1) lds=163840
.amdgcn_target "amdgcn-amd-amdhsa--gfx950"
.text
.globl gated_mix__ssm_conv_s4d__mha_block__prompt_kernel
.p2align 8
.type gated_mix__ssm_conv_s4d__mha_block__prompt_kernel,@function
gated_mix__ssm_conv_s4d__mha_block__prompt_kernel:
    s_cmp_ge_u32 s2, 256
    s_cbranch_scc1 L_end
    s_load_dwordx16 s[16:31], s[0:1], 0
    s_load_dwordx8 s[32:39], s[0:1], 64
    s_load_dwordx4 s[40:43], s[0:1], 96
    v_lshrrev_b32 v3, 6, v0
    v_and_b32 v1, 63, v0
    v_readfirstlane_b32 s3, v3
    s_getpc_b64 s[8:9]
L_pc:
    s_lshr_b32 s7, s2, 3
    s_and_b32 s71, s2, 0xc0
    s_and_b32 s6, s7, 7
    s_or_b32 s71, s71, s6
    s_and_b32 s6, s2, 7
    s_lshl3_add_u32 s71, s6, s71
    s_lshr_b32 s4, s6, 1
    s_and_b32 s10, s7, 3
    s_lshl2_add_u32 s4, s4, s10
    s_and_b32 s5, s6, 1
    s_lshr_b32 s12, s7, 2
    s_lshl3_add_u32 s5, s5, s12
    s_bfm_b32 s13, s5, 0
    s_and_b32 s13, s13, 48960
    s_bcnt1_i32_b32 s13, s13
    s_and_b32 s68, s6, 6
    s_lshl3_add_u32 s68, s13, s68
    s_and_b32 s13, s7, 1
    s_add_u32 s68, s68, s13
    s_addk_i32 s68, 512
    s_bitcmp1_b32 48960, s5
    s_cselect_b32 s68, s68, 576
    s_bitcmp1_b32 s2, 4
    s_cselect_b32 s68, s68, 576
    s_cmp_lg_u32 s3, 0
    s_cbranch_scc1 L_nopf_4
    s_and_b32 s6, s7, 3
    s_lshl_b32 s6, s6, 13
    v_lshl_add_u32 v3, v1, 7, s6
    v_min_u32 v3, L_end-L_pc, v3
    global_load_dword v3, v3, s[8:9]
    v_lshlrev_b32 v4, 2, v1
    v_add_u32 v4, 163328, v4
    v_mov_b32 v5, 0
    ds_write_b32 v4, v5
L_nopf_4:
    s_movk_i32 s66, 576
    s_mov_b32 s6, 0xcf3f
    s_bitcmp0_b32 s6, s3
    s_cbranch_scc1 L_nokg_5
    s_and_b32 s65, s3, 7
    s_sub_u32 s6, s65, 2
    s_cmp_ge_u32 s65, 6
    s_cselect_b32 s65, s6, s65
    s_lshr_b32 s66, s65, 1
    s_lshl_b32 s66, s66, 8
    s_add_u32 s66, s66, s71
    s_cmp_ge_u32 s65, 4
    s_cselect_b32 s66, s68, s66
    s_min_u32 s6, s66, 575
    s_lshl_b32 s6, s6, 1
    v_mov_b32 v124, s6
    s_and_b32 s13, s65, 1
    s_add_u32 s6, s6, s13
    s_lshl_b32 s6, s6, 7
    v_lshl_add_u32 v120, v1, 1, s6
    s_waitcnt lgkmcnt(0)
    global_load_ushort v123, v124, s[26:27]
    global_load_ushort v121, v120, s[18:19]
    global_load_ushort v122, v120, s[20:21]
    s_cmp_ge_u32 s3, 8
    s_cbranch_scc1 L_nokg_5
    global_load_ushort v126, v120, s[22:23]
    global_load_ushort v127, v120, s[24:25]
    s_mov_b32 s5, s13
    s_barrier
    s_branch L_kg_1
L_nokg_5:
    s_lshl1_add_u32 s11, s10, s12
    s_sub_u32 s8, s11, 9
    s_cmp_ge_u32 s11, 9
    s_cselect_b32 s11, s8, s11
    s_cmp_lt_u32 s3, 8
    s_cbranch_scc1 L_ld
    s_lshl_b32 s8, s5, 4
    s_add_u32 s8, s8, s3
    s_cmp_eq_u32 s8, 13
    s_cbranch_scc1 L_gate_dma
    s_barrier
    s_branch L_gemm_2
L_ld:
    v_lshrrev_b32 v10, 4, v1
    s_setprio 3
    s_mov_b32 s47, 0x20000
    s_mov_b32 s6, s11
    s_cmp_eq_u32 s3, 6
    s_cbranch_scc1 L_ldx_6
    v_and_b32 v8, 15, v1
    v_lshlrev_b32 v9, 2, v10
    v_xor_b32 v8, v8, v9
    v_lshrrev_b32 v9, 2, v8
    v_and_b32 v8, 3, v8
    v_cmp_eq_u32 vcc, 3, v9
    v_mul_u32_u24 v9, 9, v9
    v_lshrrev_b32 v11, 1, v8
    v_add_u32 v9, v9, v11
    v_lshl_add_u32 v9, v8, 1, v9
    v_min_u32 v8, 2, v8
    v_mad_u32_u24 v8, v8, 9, 4
    v_cndmask_b32 v9, v9, v8, vcc
    v_mul_u32_u24 v10, 432, v10
    s_mul_i32 s7, s5, 27
    v_add3_u32 v9, v9, v10, s7
    v_lshlrev_b32 v4, 3, v9
    s_mov_b32 s72, 4160716799
    s_mov_b32 s73, 4294442879
    s_mov_b32 s8, 221184
    s_mov_b32 s9, 55296
    s_movk_i32 s10, 16384
    s_movk_i32 s14, 12800
    s_mov_b32 s15, 0
    s_mov_b32 s46, 1990656
    s_waitcnt lgkmcnt(0)
    s_mov_b64 s[44:45], s[32:33]
    s_branch L_ldc_7
L_ldx_6:
    v_lshrrev_b32 v8, 3, v1
    s_lshl_b32 s7, s4, 7
    v_add_u32 v9, s7, v8
    v_mul_u32_u24 v9, 1152, v9
    v_and_b32 v11, 7, v1
    v_xor_b32 v11, v11, v10
    v_lshl_add_u32 v4, v11, 4, v9
    s_mov_b64 s[72:73], -1
    s_movk_i32 s8, 128
    s_mov_b32 s9, 36864
    s_mov_b32 s10, 0
    s_movk_i32 s14, 8192
    s_mov_b32 s15, 64
    s_mov_b32 s46, 2359296
    s_waitcnt lgkmcnt(0)
    s_mov_b64 s[44:45], s[16:17]
L_ldc_7:
    v_xor_b32 v5, s15, v4
    v_add_u32 v5, s14, v5
    s_lshl_b32 s14, s14, 1
    v_add_u32 v6, s14, v4
    v_add_u32 v7, s14, v5
    s_barrier
    s_add_u32 m0, s10, 0
    s_call_b64 s[12:13], L_issue_8
    s_add_u32 m0, s10, 98304
    s_call_b64 s[12:13], L_issue_8
    s_branch L_over_9
L_issue_8:
    s_mul_i32 s7, s6, s8
    s_mov_b64 exec, s[72:73]
    s_waitcnt vmcnt(20)
    buffer_load_dwordx4 v4, s[44:47], s7 offen offset:0 lds
    buffer_load_dwordx4 v5, s[44:47], s7 offen offset:1024 lds
    buffer_load_dwordx4 v6, s[44:47], s7 offen offset:2048 lds
    buffer_load_dwordx4 v7, s[44:47], s7 offen offset:3072 lds
    s_add_u32 m0, m0, 4096
    s_add_u32 s7, s7, s9
    s_waitcnt vmcnt(20)
    buffer_load_dwordx4 v4, s[44:47], s7 offen offset:0 lds
    buffer_load_dwordx4 v5, s[44:47], s7 offen offset:1024 lds
    buffer_load_dwordx4 v6, s[44:47], s7 offen offset:2048 lds
    buffer_load_dwordx4 v7, s[44:47], s7 offen offset:3072 lds
    s_add_u32 m0, m0, 4096
    s_add_u32 s7, s7, s9
    s_waitcnt vmcnt(20)
    buffer_load_dwordx4 v4, s[44:47], s7 offen offset:0 lds
    buffer_load_dwordx4 v5, s[44:47], s7 offen offset:1024 lds
    buffer_load_dwordx4 v6, s[44:47], s7 offen offset:2048 lds
    buffer_load_dwordx4 v7, s[44:47], s7 offen offset:3072 lds
    s_add_u32 m0, m0, 4096
    s_add_u32 s7, s7, s9
    s_waitcnt vmcnt(20)
    buffer_load_dwordx4 v4, s[44:47], s7 offen offset:0 lds
    buffer_load_dwordx4 v5, s[44:47], s7 offen offset:1024 lds
    buffer_load_dwordx4 v6, s[44:47], s7 offen offset:2048 lds
    buffer_load_dwordx4 v7, s[44:47], s7 offen offset:3072 lds
    s_mov_b64 exec, -1
    s_add_u32 s6, s6, 1
    s_cmp_eq_u32 s6, 9
    s_cselect_b32 s6, 0, s6
    s_setpc_b64 s[12:13]
L_over_9:
    s_mov_b32 s52, s42
    s_mov_b32 s53, s43
    s_mov_b32 s54, 13651968
    s_mov_b32 s55, 0x20000
    v_lshlrev_b32 v10, 4, v1
    v_lshrrev_b32 v16, 4, v1
    v_bfe_u32 v17, v1, 2, 2
    v_lshl_add_u32 v18, v16, 3, v17
    v_bfe_u32 v19, v18, 1, 3
    v_bfe_u32 v17, v1, 1, 1
    v_xor_b32 v19, v19, v17
    v_lshlrev_b32 v19, 4, v19
    v_lshl_add_u32 v19, v18, 7, v19
    v_and_b32 v17, 1, v1
    v_lshl_add_u32 v19, v17, 3, v19
    s_and_b32 s74, s5, 8
    s_lshl_b32 s75, s74, 3
    v_xor_b32 v20, s75, v19
    v_xor_b32 v21, 32, v20
    v_and_b32 v17, 15, v1
    v_lshlrev_b32 v17, 6, v17
    v_lshl_add_u32 v17, v16, 4, v17
    s_lshl_b32 s74, s74, 10
    s_mul_i32 s75, s4, 147456
    s_add_u32 s74, s74, s75
    s_add_u32 s74, s74, 7540736
    v_add_u32 v22, s74, v17
    s_waitcnt vmcnt(16)
    s_barrier
    s_mov_b32 s78, 0
    s_cmp_lg_u32 s3, 6
    s_cbranch_scc1 L_utskip_12
    s_lshl_b32 s74, s11, 14
    s_mov_b32 s78, 1
    ds_read_b64_tr_b16 v[24:25], v20 offset:0
    ds_read_b64_tr_b16 v[26:27], v21 offset:512
    ds_read_b64_tr_b16 v[28:29], v20 offset:4096
    ds_read_b64_tr_b16 v[30:31], v21 offset:4608
    ds_read_b64_tr_b16 v[32:33], v20 offset:8192
    ds_read_b64_tr_b16 v[34:35], v21 offset:8704
    ds_read_b64_tr_b16 v[36:37], v20 offset:12288
    ds_read_b64_tr_b16 v[38:39], v21 offset:12800
    ds_read_b64_tr_b16 v[40:41], v21 offset:0
    ds_read_b64_tr_b16 v[42:43], v20 offset:512
    ds_read_b64_tr_b16 v[44:45], v21 offset:4096
    ds_read_b64_tr_b16 v[46:47], v20 offset:4608
    ds_read_b64_tr_b16 v[48:49], v21 offset:8192
    ds_read_b64_tr_b16 v[50:51], v20 offset:8704
    ds_read_b64_tr_b16 v[52:53], v21 offset:12288
    ds_read_b64_tr_b16 v[54:55], v20 offset:12800
L_utskip_12:
    s_add_u32 m0, s10, 65536
    s_call_b64 s[12:13], L_issue_8
    s_cmp_eq_u32 s78, 0
    s_cbranch_scc1 L_utskip_13
    s_waitcnt lgkmcnt(0)
    buffer_store_dwordx4 v[24:27], v22, s[52:55], s74 offen offset:0 sc1
    buffer_store_dwordx4 v[28:31], v22, s[52:55], s74 offen offset:1024 sc1
    buffer_store_dwordx4 v[32:35], v22, s[52:55], s74 offen offset:2048 sc1
    buffer_store_dwordx4 v[36:39], v22, s[52:55], s74 offen offset:3072 sc1
    s_add_u32 s74, s74, 4096
    buffer_store_dwordx4 v[40:43], v22, s[52:55], s74 offen offset:0 sc1
    buffer_store_dwordx4 v[44:47], v22, s[52:55], s74 offen offset:1024 sc1
    buffer_store_dwordx4 v[48:51], v22, s[52:55], s74 offen offset:2048 sc1
    buffer_store_dwordx4 v[52:55], v22, s[52:55], s74 offen offset:3072 sc1
L_utskip_13:
    s_waitcnt vmcnt(24)
    s_cmp_eq_u32 s78, 1
    s_cbranch_scc1 L_w24_14
    s_waitcnt vmcnt(16)
L_w24_14:
    s_barrier
    s_mov_b32 s78, 0
    s_cmp_lg_u32 s3, 6
    s_cbranch_scc1 L_utskip_15
    s_and_b32 s74, s5, 7
    s_cmp_lg_u32 s74, 7
    s_cbranch_scc1 L_utskip_15
    s_add_u32 s74, s11, 1
    s_cmp_eq_u32 s74, 9
    s_cselect_b32 s74, 0, s74
    s_lshl_b32 s74, s74, 14
    v_add_u32 v20, 98304, v20
    v_add_u32 v21, 98304, v21
    s_mov_b32 s78, 1
    ds_read_b64_tr_b16 v[56:57], v20 offset:0
    ds_read_b64_tr_b16 v[58:59], v21 offset:512
    ds_read_b64_tr_b16 v[60:61], v20 offset:4096
    ds_read_b64_tr_b16 v[62:63], v21 offset:4608
    ds_read_b64_tr_b16 v[64:65], v20 offset:8192
    ds_read_b64_tr_b16 v[66:67], v21 offset:8704
    ds_read_b64_tr_b16 v[68:69], v20 offset:12288
    ds_read_b64_tr_b16 v[70:71], v21 offset:12800
    ds_read_b64_tr_b16 v[72:73], v21 offset:0
    ds_read_b64_tr_b16 v[74:75], v20 offset:512
    ds_read_b64_tr_b16 v[76:77], v21 offset:4096
    ds_read_b64_tr_b16 v[78:79], v20 offset:4608
    ds_read_b64_tr_b16 v[80:81], v21 offset:8192
    ds_read_b64_tr_b16 v[82:83], v20 offset:8704
    ds_read_b64_tr_b16 v[84:85], v21 offset:12288
    ds_read_b64_tr_b16 v[86:87], v20 offset:12800
L_utskip_15:
    s_add_u32 m0, s10, 32768
    s_call_b64 s[12:13], L_issue_8
    s_cmp_eq_u32 s78, 0
    s_cbranch_scc1 L_utskip_16
    s_waitcnt lgkmcnt(0)
    buffer_store_dwordx4 v[56:59], v22, s[52:55], s74 offen offset:0 sc1
    buffer_store_dwordx4 v[60:63], v22, s[52:55], s74 offen offset:1024 sc1
    buffer_store_dwordx4 v[64:67], v22, s[52:55], s74 offen offset:2048 sc1
    buffer_store_dwordx4 v[68:71], v22, s[52:55], s74 offen offset:3072 sc1
    s_add_u32 s74, s74, 4096
    buffer_store_dwordx4 v[72:75], v22, s[52:55], s74 offen offset:0 sc1
    buffer_store_dwordx4 v[76:79], v22, s[52:55], s74 offen offset:1024 sc1
    buffer_store_dwordx4 v[80:83], v22, s[52:55], s74 offen offset:2048 sc1
    buffer_store_dwordx4 v[84:87], v22, s[52:55], s74 offen offset:3072 sc1
L_utskip_16:
    s_waitcnt vmcnt(24)
    s_cmp_eq_u32 s78, 1
    s_cbranch_scc1 L_w24_17
    s_waitcnt vmcnt(16)
L_w24_17:
    s_barrier
    s_add_u32 m0, s10, 0
    s_call_b64 s[12:13], L_issue_8
    s_waitcnt vmcnt(16)
    s_barrier
    s_add_u32 m0, s10, 98304
    s_call_b64 s[12:13], L_issue_8
    s_waitcnt vmcnt(16)
    s_barrier
    s_add_u32 m0, s10, 65536
    s_call_b64 s[12:13], L_issue_8
    s_waitcnt vmcnt(16)
    s_barrier
    s_add_u32 m0, s10, 32768
    s_call_b64 s[12:13], L_issue_8
    s_waitcnt vmcnt(16)
    s_barrier
    s_add_u32 m0, s10, 0
    s_call_b64 s[12:13], L_issue_8
    s_waitcnt vmcnt(16)
    s_barrier
    s_and_b32 s69, s3, 12
    s_add_u32 s69, s69, 163328
    v_mov_b32 v8, 163328
    v_mov_b32 v9, s69
    ds_read_b32 v8, v8 offset:224
    ds_read_b32 v9, v9 offset:228
    s_waitcnt lgkmcnt(0)
    v_readfirstlane_b32 s30, v8
    v_readfirstlane_b32 s70, v9
    s_nop 1
    s_waitcnt vmcnt(0)
    s_barrier
    s_branch L_p1end_3
L_kg_1:
    s_cmp_ge_u32 s66, 576
    s_cbranch_scc1 L_kgskip_18
    s_lshr_b32 s14, s3, 1
    s_mul_i32 s6, s3, 4608
    s_add_u32 s6, s6, 131072
    s_mov_b32 s9, 1069066811
    s_mov_b32 s10, 849703008
    s_mov_b32 s11, 1042479491
    s_mov_b32 s12, 836541576
    s_mov_b32 s13, 1060205080
    v_lshl_add_u32 v4, v1, 2, s6
    v_add_u32 v5, 1088, v4
    v_add_u32 v6, 2176, v4
    v_add_u32 v7, 3264, v4
    v_lshrrev_b32 v125, 5, v1
    v_lshlrev_b32 v125, 4, v125
    v_and_b32 v124, 15, v1
    v_mul_u32_u24 v124, 272, v124
    v_add3_u32 v8, v124, v125, s6
    v_and_b32 v124, 31, v1
    v_mul_u32_u24 v124, 272, v124
    s_mul_i32 s7, s3, 8704
    s_add_u32 s7, s7, 32768
    v_add3_u32 v9, v124, v125, s7
    v_lshl_add_u32 v17, v1, 2, s7
    s_lshl_b32 s15, s3, 2
    s_add_u32 s15, s15, 163328
    s_waitcnt vmcnt(0)
    v_lshlrev_b32 v126, 16, v126
    v_lshlrev_b32 v127, 16, v127
    v_max_f32 v124, |v126|, |v127|
    v_lshlrev_b32 v123, 16, v123
    v_lshlrev_b32 v121, 16, v121
    v_mul_f32 v20, s9, v123
    v_max_u32_dpp v124, v124, v124 row_shr:1
    v_mul_f32 v22, s9, v121
    v_fma_f32 v21, v123, s9, -v20
    v_fma_f32 v23, v121, s9, -v22
    v_max_u32_dpp v124, v124, v124 row_shr:2
    v_exp_f32 v20, v20
    v_exp_f32 v22, v22
    v_fma_f32 v21, v123, s10, v21
    v_max_u32_dpp v124, v124, v124 row_shr:4
    v_fma_f32 v23, v121, s10, v23
    v_mul_f32 v21, s13, v21
    v_mul_f32 v23, s13, v23
    v_max_u32_dpp v124, v124, v124 row_shr:8
    v_fma_f32 v123, v20, v21, v20
    v_fma_f32 v121, v22, v23, v22
    v_cvt_pk_bf16_f32 v123, v123, v123
    v_max_u32_dpp v124, v124, v124 row_bcast:15 row_mask:0xa
    v_cvt_pk_bf16_f32 v121, v121, v121
    v_and_b32 v123, 0xffff0000, v123
    v_and_b32 v121, 0xffff0000, v121
    v_max_u32_dpp v124, v124, v124 row_bcast:31 row_mask:0xc
    v_lshlrev_b32 v122, 16, v122
    v_mul_f32 v121, v121, v123
    v_mul_f32 v122, v122, v123
    v_mul_f32 v10, s9, -v121
    v_mul_f32 v11, s11, v122
    v_fma_f32 v12, v122, s11, -v11
    v_fma_f32 v12, v122, s12, v12
    v_readlane_b32 s8, v124, 63
    v_mul_f32 v20, 1065353216, v11
    v_mul_f32 v22, 1132462080, v11
    v_mul_f32 v24, 1149239296, v11
    v_mul_f32 v21, 1065353216, v10
    v_mul_f32 v23, 1132462080, v10
    v_mul_f32 v25, 1149239296, v10
    v_fract_f32 v20, v20
    v_fract_f32 v22, v22
    v_fract_f32 v24, v24
    v_exp_f32 v21, v21
    v_exp_f32 v23, v23
    v_exp_f32 v25, v25
    v_fmac_f32 v20, 1065353216, v12
    v_fmac_f32 v22, 1132462080, v12
    v_fmac_f32 v24, 1149239296, v12
    v_cos_f32 v84, v20
    v_cos_f32 v90, v22
    v_cos_f32 v94, v24
    v_sin_f32 v85, v20
    v_sin_f32 v91, v22
    v_sin_f32 v95, v24
    v_mul_f32 v84, v84, v21
    v_mul_f32 v90, v90, v23
    v_mul_f32 v94, v94, v25
    v_mul_f32 v85, v85, v21
    v_mul_f32 v91, v91, v23
    v_mul_f32 v95, v95, v25
    s_lshr_b32 s8, s8, 23
    s_max_u32 s8, s8, 1
    s_min_u32 s8, s8, 252
    s_sub_u32 s7, 253, s8
    s_lshl_b32 s7, s7, 23
    v_mul_f32 v126, s7, v126
    v_mul_f32 v127, s7, v127
    s_add_u32 s8, s8, 2
    s_lshl_b32 s8, s8, 23
    v_mul_f32 v13, s8, v123
    v_mul_f32 v86, v85, v85
    v_mul_f32 v92, v91, v91
    v_mul_f32 v104, v127, v95
    v_mul_f32 v87, v85, v84
    v_mul_f32 v93, v91, v90
    v_mul_f32 v105, v127, v94
    v_fma_f32 v86, v84, v84, -v86
    v_fma_f32 v92, v90, v90, -v92
    v_fma_f32 v104, v126, v94, -v104
    v_fmac_f32 v87, v84, v85
    v_fmac_f32 v93, v90, v91
    v_fmac_f32 v105, v126, v95
    v_mul_f32 v88, v87, v87
    v_mul_f32 v96, v127, v87
    v_mul_f32 v102, v91, v93
    v_mul_f32 v89, v87, v86
    v_mul_f32 v97, v127, v86
    v_mul_f32 v103, v91, v92
    v_fma_f32 v88, v86, v86, -v88
    v_fma_f32 v96, v126, v86, -v96
    v_fma_f32 v102, v90, v92, -v102
    v_fmac_f32 v89, v86, v87
    v_fmac_f32 v97, v126, v87
    v_fmac_f32 v103, v90, v93
    v_mul_f32 v98, v127, v89
    v_mul_f32 v100, v97, v89
    v_mul_f32 v99, v127, v88
    v_mul_f32 v101, v97, v88
    v_fma_f32 v98, v126, v88, -v98
    v_fma_f32 v100, v96, v88, -v100
    v_fmac_f32 v99, v126, v89
    v_fmac_f32 v101, v96, v89
    v_cvt_pk_f16_f32 v108, v126, v127
    v_cvt_pk_f16_f32 v112, v84, v85
    v_cvt_pk_f16_f32 v109, v96, v97
    v_cvt_pk_f16_f32 v113, v90, v91
    v_cvt_pk_f16_f32 v114, v92, v93
    v_cvt_pk_f16_f32 v115, v102, v103
    v_cvt_pk_f16_f32 v116, v94, v95
    v_cvt_pk_f16_f32 v117, v104, v105
    v_cvt_pk_f16_f32 v110, v98, v99
    v_cvt_pk_f16_f32 v111, v100, v101
    v_pk_mul_f16 v21, v117, v113 op_sel:[0,0] op_sel_hi:[0,1]
    v_pk_mul_f16 v22, v117, v114 op_sel:[0,0] op_sel_hi:[0,1]
    v_pk_mul_f16 v23, v117, v115 op_sel:[0,0] op_sel_hi:[0,1]
    v_pk_fma_f16 v21, v117, v113, v21 op_sel:[1,1,0] op_sel_hi:[1,0,1] neg_lo:[1,0,0]
    v_pk_fma_f16 v22, v117, v114, v22 op_sel:[1,1,0] op_sel_hi:[1,0,1] neg_lo:[1,0,0]
    v_pk_fma_f16 v23, v117, v115, v23 op_sel:[1,1,0] op_sel_hi:[1,0,1] neg_lo:[1,0,0]
    ds_write2_b32 v4, v117, v21 offset0:0 offset1:68
    ds_write2_b32 v4, v22, v23 offset0:136 offset1:204
    v_pk_mul_f16 v24, v117, v116 op_sel:[0,0] op_sel_hi:[0,1]
    v_pk_fma_f16 v24, v117, v116, v24 op_sel:[1,1,0] op_sel_hi:[1,0,1] neg_lo:[1,0,0]
    ds_write_b32 v5, v24 offset:0
    s_mov_b32 exec_lo, 4294901760
    s_mov_b32 exec_hi, 4294901760
    ds_read_b128 v[52:55], v8 offset:0
    ds_read_b128 v[56:59], v8 offset:32
    ds_read_b128 v[60:63], v8 offset:64
    ds_read_b128 v[64:67], v8 offset:96
    ds_read_b128 v[68:71], v8 offset:128
    ds_read_b128 v[72:75], v8 offset:160
    ds_read_b128 v[76:79], v8 offset:192
    ds_read_b128 v[80:83], v8 offset:224
    s_mov_b64 exec, -1
    v_pk_mul_f16 v21, v108, v112 op_sel:[0,0] op_sel_hi:[0,1]
    v_pk_mul_f16 v23, v109, v112 op_sel:[0,0] op_sel_hi:[0,1]
    v_pk_fma_f16 v21, v108, v112, v21 op_sel:[1,1,0] op_sel_hi:[1,0,1] neg_lo:[1,0,0]
    v_pk_fma_f16 v23, v109, v112, v23 op_sel:[1,1,0] op_sel_hi:[1,0,1] neg_lo:[1,0,0]
    ds_write2_b32 v4, v108, v21 offset0:0 offset1:68
    ds_write2_b32 v4, v109, v23 offset0:136 offset1:204
    v_pk_mul_f16 v25, v110, v112 op_sel:[0,0] op_sel_hi:[0,1]
    v_pk_mul_f16 v27, v111, v112 op_sel:[0,0] op_sel_hi:[0,1]
    v_pk_fma_f16 v25, v110, v112, v25 op_sel:[1,1,0] op_sel_hi:[1,0,1] neg_lo:[1,0,0]
    v_pk_fma_f16 v27, v111, v112, v27 op_sel:[1,1,0] op_sel_hi:[1,0,1] neg_lo:[1,0,0]
    ds_write2_b32 v5, v110, v25 offset0:0 offset1:68
    ds_write2_b32 v5, v111, v27 offset0:136 offset1:204
    v_pk_mul_f16 v20, v108, v113 op_sel:[0,0] op_sel_hi:[0,1]
    v_pk_mul_f16 v21, v109, v113 op_sel:[0,0] op_sel_hi:[0,1]
    v_pk_mul_f16 v22, v110, v113 op_sel:[0,0] op_sel_hi:[0,1]
    v_pk_mul_f16 v23, v111, v113 op_sel:[0,0] op_sel_hi:[0,1]
    v_pk_fma_f16 v20, v108, v113, v20 op_sel:[1,1,0] op_sel_hi:[1,0,1] neg_lo:[1,0,0]
    v_pk_fma_f16 v21, v109, v113, v21 op_sel:[1,1,0] op_sel_hi:[1,0,1] neg_lo:[1,0,0]
    v_pk_fma_f16 v22, v110, v113, v22 op_sel:[1,1,0] op_sel_hi:[1,0,1] neg_lo:[1,0,0]
    v_pk_fma_f16 v23, v111, v113, v23 op_sel:[1,1,0] op_sel_hi:[1,0,1] neg_lo:[1,0,0]
    ds_write2_b32 v6, v20, v21 offset0:0 offset1:68
    ds_write2_b32 v6, v22, v23 offset0:136 offset1:204
    v_pk_mul_f16 v24, v108, v114 op_sel:[0,0] op_sel_hi:[0,1]
    v_pk_mul_f16 v25, v110, v114 op_sel:[0,0] op_sel_hi:[0,1]
    v_pk_mul_f16 v26, v108, v115 op_sel:[0,0] op_sel_hi:[0,1]
    v_pk_mul_f16 v27, v110, v115 op_sel:[0,0] op_sel_hi:[0,1]
    v_pk_fma_f16 v24, v108, v114, v24 op_sel:[1,1,0] op_sel_hi:[1,0,1] neg_lo:[1,0,0]
    v_pk_fma_f16 v25, v110, v114, v25 op_sel:[1,1,0] op_sel_hi:[1,0,1] neg_lo:[1,0,0]
    v_pk_fma_f16 v26, v108, v115, v26 op_sel:[1,1,0] op_sel_hi:[1,0,1] neg_lo:[1,0,0]
    v_pk_fma_f16 v27, v110, v115, v27 op_sel:[1,1,0] op_sel_hi:[1,0,1] neg_lo:[1,0,0]
    ds_write2_b32 v7, v24, v25 offset0:0 offset1:68
    ds_write2_b32 v7, v26, v27 offset0:136 offset1:204
    s_mov_b32 exec_lo, 65535
    s_mov_b32 exec_hi, 65535
    ds_read_b128 v[52:55], v8 offset:0
    ds_read_b128 v[56:59], v8 offset:32
    ds_read_b128 v[60:63], v8 offset:64
    ds_read_b128 v[64:67], v8 offset:96
    ds_read_b128 v[68:71], v8 offset:128
    ds_read_b128 v[72:75], v8 offset:160
    ds_read_b128 v[76:79], v8 offset:192
    ds_read_b128 v[80:83], v8 offset:224
    s_mov_b64 exec, -1
    v_and_b32 v120, 31, v1
    v_lshrrev_b32 v121, 5, v1
    v_lshlrev_b32 v122, 3, v120
    v_lshl_add_u32 v122, v121, 2, v122
    v_cmp_eq_u32 vcc, 0, v121
    v_lshlrev_b32 v123, 2, v120
    v_lshlrev_b32 v124, 1, v120
    v_add_u32 v124, 128, v124
    v_cndmask_b32 v123, v124, v123, vcc
    v_lshl_add_u32 v125, v121, 7, v120
    v_and_b32 v120, 0xff0, v122
    v_lshl_add_u32 v122, v122, 2, v120
    v_add_u32 v122, s6, v122
    v_and_b32 v120, 0xff0, v123
    v_lshl_add_u32 v123, v123, 2, v120
    v_add_u32 v123, s6, v123
    v_mul_u32_u24 v124, 312, v121
    v_add_u32 v124, v124, v123
    v_and_b32 v120, 0xff0, v125
    v_lshl_add_u32 v125, v125, 2, v120
    v_add_u32 v125, s6, v125
    v_mov_b32 v20, s15
    s_mov_b32 s31, 524288
L_sglspin_1:
    ds_read_b32 v21, v20 offset:160
    s_waitcnt lgkmcnt(0)
    v_readfirstlane_b32 s8, v21
    s_cmp_ge_u32 s8, 1
    s_cbranch_scc1 L_sglsdone_2
    s_sleep 1
    s_sub_u32 s31, s31, 1
    s_cbranch_scc0 L_sglspin_1
L_sglsdone_2:
    ds_read_b128 v[20:23], v9 offset:0
    ds_read_b128 v[24:27], v9 offset:32
    ds_read_b128 v[28:31], v9 offset:64
    ds_read_b128 v[32:35], v9 offset:96
    ds_read_b128 v[36:39], v9 offset:128
    ds_read_b128 v[40:43], v9 offset:160
    ds_read_b128 v[44:47], v9 offset:192
    ds_read_b128 v[48:51], v9 offset:224
    s_waitcnt lgkmcnt(7)
    v_mfma_f32_32x32x16_f16 v[84:99], v[52:55], v[20:23], 0
    s_waitcnt lgkmcnt(6)
    v_mfma_f32_32x32x16_f16 v[84:99], v[56:59], v[24:27], v[84:99]
    s_waitcnt lgkmcnt(5)
    v_mfma_f32_32x32x16_f16 v[84:99], v[60:63], v[28:31], v[84:99]
    s_waitcnt lgkmcnt(4)
    v_mfma_f32_32x32x16_f16 v[84:99], v[64:67], v[32:35], v[84:99]
    s_waitcnt lgkmcnt(3)
    v_mfma_f32_32x32x16_f16 v[84:99], v[68:71], v[36:39], v[84:99]
    s_waitcnt lgkmcnt(2)
    v_mfma_f32_32x32x16_f16 v[84:99], v[72:75], v[40:43], v[84:99]
    s_waitcnt lgkmcnt(1)
    v_mfma_f32_32x32x16_f16 v[84:99], v[76:79], v[44:47], v[84:99]
    s_waitcnt lgkmcnt(0)
    v_mfma_f32_32x32x16_f16 v[84:99], v[80:83], v[48:51], v[84:99]
    s_mul_i32 s7, s5, 4608
    s_sub_u32 s7, s6, s7
    s_sub_u32 s7, s7, 738197504
    s_nop 12
    v_mul_f32 v84, v13, v84
    v_mul_f32 v85, v13, v85
    v_mul_f32 v86, v13, v86
    v_mul_f32 v87, v13, v87
    v_mul_f32 v88, v13, v88
    v_mul_f32 v89, v13, v89
    v_mul_f32 v90, v13, v90
    v_mul_f32 v91, v13, v91
    v_mul_f32 v92, v13, v92
    v_mul_f32 v93, v13, v93
    v_mul_f32 v94, v13, v94
    v_mul_f32 v95, v13, v95
    ds_write_b128 v122, v[84:87] offset:80
    ds_write_b64 v123, v[88:89] offset:1360
    ds_write_b64 v124, v[90:91] offset:1368
    ds_write_b32 v125, v92 offset:2640
    ds_write_b32 v125, v93 offset:2800
    ds_write_b32 v125, v94 offset:2960
    ds_write_b32 v125, v95 offset:3120
    s_waitcnt lgkmcnt(0)
    s_barrier
    s_mov_b32 s52, s42
    s_mov_b32 s53, s43
    s_mov_b32 s54, 13651968
    s_mov_b32 s55, 0x20000
    s_and_b32 s69, s3, 12
    s_add_u32 s69, s69, 163328
    v_mov_b32 v4, 163328
    v_mov_b32 v5, s69
    ds_read_b32 v4, v4 offset:224
    ds_read_b32 v5, v5 offset:228
    s_waitcnt lgkmcnt(0)
    v_readfirstlane_b32 s30, v4
    v_readfirstlane_b32 s70, v5
    s_nop 1
    s_lshr_b32 s8, s66, 6
    v_and_b32 v10, 3, v1
    v_lshlrev_b32 v10, 1, v10
    v_sub_u32 v10, s8, v10
    v_add_u32 v11, 9, v10
    v_min3_u32 v10, v10, v11, 7
    s_and_b32 s8, s66, 32
    s_lshl_b32 s8, s8, 2
    v_lshl_add_u32 v10, v10, 4, s8
    v_add_lshl_u32 v10, v10, v1, 7
    v_add_u32 v10, 4096, v10
    s_lshl_b32 s8, s5, 7
    s_sub_u32 s8, 255, s8
    v_sub_u32 v124, s8, v1
    v_lshlrev_b32 v124, 3, v124
    v_max_u32 v125, 128, v124
    v_cvt_f32_u32 v125, v125
    v_and_b32 v14, 0x7f800000, v125
    v_sub_u32 v14, 2189426688, v14
    v_lshrrev_b32 v125, 16, v125
    v_subrev_u32 v125, 17024, v125
    v_min_u32 v125, v125, v124
    v_add_u32 v16, 0x4b000010, v125
    v_max_u32 v125, 129, v124
    v_subrev_u32 v125, 1, v125
    v_cvt_f32_u32 v125, v125
    v_and_b32 v15, 0x7f800000, v125
    v_sub_u32 v15, 2189426688, v15
    v_fmamk_f32 v84, v14, 1088421888, v16
    v_and_b32 v120, 0xff0, v84
    v_lshl_add_u32 v84, v84, 2, s7
    v_add_u32 v84, v84, v120
    ds_read2st64_b32 v[20:21], v84 offset0:0 offset1:18
    v_fmamk_f32 v85, v14, 1086324736, v16
    s_barrier
    v_and_b32 v121, 0xff0, v85
    v_lshl_add_u32 v85, v85, 2, s7
    v_add_u32 v85, v85, v121
    ds_read2st64_b32 v[22:23], v85 offset0:0 offset1:18
    v_fmamk_f32 v86, v14, 1084227584, v16
    v_and_b32 v120, 0xff0, v86
    v_lshl_add_u32 v86, v86, 2, s7
    v_add_u32 v86, v86, v120
    ds_read2st64_b32 v[24:25], v86 offset0:0 offset1:18
    v_fmamk_f32 v87, v14, 1082130432, v16
    v_and_b32 v121, 0xff0, v87
    v_lshl_add_u32 v87, v87, 2, s7
    v_add_u32 v87, v87, v121
    ds_read2st64_b32 v[26:27], v87 offset0:0 offset1:18
    v_fmamk_f32 v88, v14, 1077936128, v16
    v_and_b32 v120, 0xff0, v88
    v_lshl_add_u32 v88, v88, 2, s7
    v_add_u32 v88, v88, v120
    ds_read2st64_b32 v[28:29], v88 offset0:0 offset1:18
    v_fmamk_f32 v89, v14, 1073741824, v16
    v_and_b32 v121, 0xff0, v89
    v_lshl_add_u32 v89, v89, 2, s7
    v_add_u32 v89, v89, v121
    ds_read2st64_b32 v[30:31], v89 offset0:0 offset1:18
    v_fmamk_f32 v90, v14, 1065353216, v16
    v_and_b32 v120, 0xff0, v90
    s_barrier
    v_lshl_add_u32 v90, v90, 2, s7
    v_add_u32 v90, v90, v120
    ds_read2st64_b32 v[32:33], v90 offset0:0 offset1:18
    v_fmamk_f32 v91, v14, 0, v16
    v_and_b32 v121, 0xff0, v91
    v_lshl_add_u32 v91, v91, 2, s7
    v_add_u32 v91, v91, v121
    ds_read2st64_b32 v[34:35], v91 offset0:0 offset1:18
    v_fmamk_f32 v92, v15, 3212836864, v16
    v_and_b32 v120, 0xff0, v92
    v_lshl_add_u32 v92, v92, 2, s7
    v_add_u32 v92, v92, v120
    ds_read2st64_b32 v[36:37], v92 offset0:0 offset1:18
    s_lshl_b32 s8, s5, 7
    s_sub_u32 s8, 191, s8
    v_sub_u32 v124, s8, v1
    v_lshlrev_b32 v124, 3, v124
    v_max_u32 v125, 128, v124
    v_cvt_f32_u32 v125, v125
    v_and_b32 v14, 0x7f800000, v125
    v_sub_u32 v14, 2189426688, v14
    v_lshrrev_b32 v125, 16, v125
    v_subrev_u32 v125, 17024, v125
    v_min_u32 v125, v125, v124
    v_add_u32 v16, 0x4b000010, v125
    v_max_u32 v125, 129, v124
    v_subrev_u32 v125, 1, v125
    v_cvt_f32_u32 v125, v125
    v_and_b32 v15, 0x7f800000, v125
    v_sub_u32 v15, 2189426688, v15
    s_barrier
    s_cmp_lg_u32 s3, 0
    s_cbranch_scc1 L_nofu_20
    s_and_b32 s76, s2, 1
    s_lshl_b32 s76, s76, 3
    s_lshr_b32 s77, s2, 5
    s_add_u32 s76, s76, s77
    s_lshl_b32 s76, s76, 2
    s_bfe_u32 s77, s2, 0x20001
    s_add_u32 s76, s76, s77
    s_lshl_b32 s76, s76, 2
    s_bfe_u32 s77, s2, 0x20003
    s_add_u32 s76, s76, s77
    s_lshl_b32 s76, s76, 7
    s_add_u32 s76, s76, 4096
    v_mov_b32 v4, s30
    v_lshlrev_b32 v5, 2, v1
    s_mov_b64 exec, 0xffff
    buffer_store_dword v4, v5, s[52:55], s76 offen sc1
    s_mov_b64 exec, -1
L_nofu_20:
    v_cmp_ne_u32 s[74:75], 0, v124
    v_fmamk_f32 v93, v14, 1088421888, v16
    v_and_b32 v121, 0xff0, v93
    v_lshl_add_u32 v93, v93, 2, s7
    v_add_u32 v93, v93, v121
    ds_read2st64_b32 v[38:39], v93 offset0:0 offset1:18
    v_fmamk_f32 v94, v14, 1086324736, v16
    v_and_b32 v120, 0xff0, v94
    v_lshl_add_u32 v94, v94, 2, s7
    v_add_u32 v94, v94, v120
    ds_read2st64_b32 v[40:41], v94 offset0:0 offset1:18
    v_fmamk_f32 v95, v14, 1084227584, v16
    v_and_b32 v121, 0xff0, v95
    v_lshl_add_u32 v95, v95, 2, s7
    v_add_u32 v95, v95, v121
    ds_read2st64_b32 v[42:43], v95 offset0:0 offset1:18
    v_fmamk_f32 v96, v14, 1082130432, v16
    v_and_b32 v120, 0xff0, v96
    v_lshl_add_u32 v96, v96, 2, s7
    v_add_u32 v96, v96, v120
    ds_read2st64_b32 v[44:45], v96 offset0:0 offset1:18
    v_fmamk_f32 v97, v14, 1077936128, v16
    v_and_b32 v121, 0xff0, v97
    v_lshl_add_u32 v97, v97, 2, s7
    v_add_u32 v97, v97, v121
    ds_read2st64_b32 v[46:47], v97 offset0:0 offset1:18
    s_barrier
    v_fmamk_f32 v98, v14, 1073741824, v16
    v_and_b32 v120, 0xff0, v98
    v_lshl_add_u32 v98, v98, 2, s7
    v_add_u32 v98, v98, v120
    ds_read2st64_b32 v[48:49], v98 offset0:0 offset1:18
    v_fmamk_f32 v99, v14, 1065353216, v16
    v_and_b32 v121, 0xff0, v99
    v_lshl_add_u32 v99, v99, 2, s7
    v_add_u32 v99, v99, v121
    ds_read2st64_b32 v[50:51], v99 offset0:0 offset1:18
    v_fmamk_f32 v100, v14, 0, v16
    v_and_b32 v120, 0xff0, v100
    v_lshl_add_u32 v100, v100, 2, s7
    v_add_u32 v100, v100, v120
    ds_read2st64_b32 v[52:53], v100 offset0:0 offset1:18
    v_fmamk_f32 v101, v15, 3212836864, v16
    v_and_b32 v121, 0xff0, v101
    v_lshl_add_u32 v101, v101, 2, s7
    v_add_u32 v101, v101, v121
    ds_read2st64_b32 v[54:55], v101 offset0:0 offset1:18
    s_mul_i32 s6, s14, 21248
    s_add_u32 s6, s6, 98304
    v_lshrrev_b32 v12, 4, v1
    v_mul_u32_u24 v12, 147456, v12
    v_and_b32 v13, 12, v1
    v_lshl_add_u32 v12, v13, 8, v12
    v_and_b32 v13, 3, v1
    v_lshl_add_u32 v12, v13, 4, v12
    s_barrier
    s_cmp_lg_u32 s5, 0
    s_cbranch_scc1 L_np_21
    s_mov_b64 exec, 0xffff
    buffer_load_dword v11, v10, s[52:55], 0 offen offset:0 sc1
    s_mov_b64 exec, -1
L_np_21:
    s_and_b32 s10, s66, 15
    s_lshl_b32 s10, s10, 6
    s_lshr_b32 s9, s66, 4
    s_lshl_b32 s9, s9, 12
    s_add_u32 s9, s9, s10
    s_add_u32 s9, s9, 7540736
    v_lshl_add_u32 v13, v1, 3, s6
    v_mov_b32 v123, 0
    s_lshl_b32 s8, s5, 11
    s_add_u32 s8, s8, s6
    v_lshl_add_u32 v120, v1, 4, s8
    v_lshrrev_b32 v121, 4, v1
    v_mul_u32_u24 v121, 4160, v121
    v_and_b32 v122, 15, v1
    v_lshl_add_u32 v121, v122, 2, v121
    s_add_u32 s7, s6, 4096
    v_add_u32 v121, s7, v121
    v_mov_b32 v122, 0
    s_waitcnt lgkmcnt(0)
    v_add_f32 v20, v20, v21
    v_add_f32 v22, v22, v23
    v_add_f32 v24, v24, v25
    s_barrier
    v_add_f32 v26, v26, v27
    v_add_f32 v28, v28, v29
    v_add_f32 v30, v30, v31
    v_add_f32 v32, v32, v33
    v_add_f32 v34, v34, v35
    v_add_f32 v36, v36, v37
    v_add_f32 v38, v38, v39
    v_add_f32 v40, v40, v41
    v_add_f32 v42, v42, v43
    v_add_f32 v44, v44, v45
    v_add_f32 v46, v46, v47
    v_add_f32 v48, v48, v49
    v_add_f32 v50, v50, v51
    v_add_f32 v52, v52, v53
    v_add_f32 v54, v54, v55
    v_cndmask_b32 v54, 0, v54, s[74:75]
    v_cvt_pk_bf16_f32 v84, v20, v22
    v_cvt_pk_bf16_f32 v85, v24, v26
    v_cvt_pk_bf16_f32 v86, v28, v30
    v_cvt_pk_bf16_f32 v87, v32, v34
    v_cvt_pk_bf16_f32 v88, v38, v40
    v_cvt_pk_bf16_f32 v89, v42, v44
    v_cvt_pk_bf16_f32 v90, v46, v48
    v_cvt_pk_bf16_f32 v91, v50, v52
    v_cvt_pk_bf16_f32 v92, v22, v24
    v_cvt_pk_bf16_f32 v93, v26, v28
    v_cvt_pk_bf16_f32 v94, v30, v32
    v_cvt_pk_bf16_f32 v95, v34, v36
    v_cvt_pk_bf16_f32 v96, v40, v42
    v_cvt_pk_bf16_f32 v97, v44, v46
    v_cvt_pk_bf16_f32 v98, v48, v50
    v_cvt_pk_bf16_f32 v99, v52, v54
    s_barrier
    s_mov_b32 s10, s5
    s_setprio 3
    s_cmp_lg_u32 s10, 0
    s_cbranch_scc1 L_no_26
    s_mov_b64 exec, 0xffff
    s_waitcnt vmcnt(0)
    v_cmp_ne_u32 vcc, s30, v11
    s_cbranch_vccnz L_re_27
    s_mov_b32 s10, 1
    s_mov_b64 exec, -1
    s_add_u32 m0, s6, 17152
    s_nop 0
    buffer_load_dwordx4 v12, s[52:55], s9 offen offset:0 sc1 lds
    s_add_u32 s9, s9, 588800
    buffer_load_dwordx4 v12, s[52:55], s9 offen offset:1024 sc1 lds
    s_add_u32 s9, s9, 588800
    buffer_load_dwordx4 v12, s[52:55], s9 offen offset:2048 sc1 lds
    s_add_u32 s9, s9, 588800
    buffer_load_dwordx4 v12, s[52:55], s9 offen offset:3072 sc1 lds
    s_branch L_no_26
L_re_27:
    buffer_load_dword v11, v10, s[52:55], 0 offen offset:0 sc1
    s_mov_b64 exec, -1
L_no_26:
    s_barrier
    ds_write_b128 v120, v[84:87] offset:0
    ds_write_b128 v120, v[88:91] offset:1024
    ds_write_b128 v120, v[92:95] offset:4160
    ds_write_b128 v120, v[96:99] offset:5184
    s_cmp_eq_u32 s5, 0
    s_cbranch_scc1 L_nz
    ds_write_b32 v121, v122
    ds_write_b64 v13, v[122:123] offset:16640
L_nz:
    s_cmp_lg_u32 s10, 0
    s_cbranch_scc1 L_uw_28
    s_mov_b64 exec, 0xffff
    s_mov_b32 s31, 524288
    s_branch L_pollchk_30
L_poll_29:
    buffer_load_dword v11, v10, s[52:55], 0 offen offset:0 sc1
L_pollchk_30:
    s_waitcnt vmcnt(0)
    v_cmp_ne_u32 vcc, s30, v11
    s_cbranch_vccz L_polld_31
    s_sleep 6
    s_sub_u32 s31, s31, 1
    s_cbranch_scc0 L_poll_29
L_polld_31:
    s_mov_b64 exec, -1
    s_add_u32 m0, s6, 17152
    s_nop 0
    buffer_load_dwordx4 v12, s[52:55], s9 offen offset:0 sc1 lds
    s_add_u32 s9, s9, 588800
    buffer_load_dwordx4 v12, s[52:55], s9 offen offset:1024 sc1 lds
    s_add_u32 s9, s9, 588800
    buffer_load_dwordx4 v12, s[52:55], s9 offen offset:2048 sc1 lds
    s_add_u32 s9, s9, 588800
    buffer_load_dwordx4 v12, s[52:55], s9 offen offset:3072 sc1 lds
L_uw_28:
    s_waitcnt vmcnt(0)
    s_lshl_b32 s7, s14, 2
    s_add_u32 s7, s7, 163328
    v_mov_b32 v120, s7
    v_mov_b32 v121, 1
    s_mov_b64 exec, 1
    ds_add_u32 v120, v121 offset:0
    s_mov_b64 exec, -1
    s_branch L_kgend_19
L_kgskip_18:
    s_barrier
    s_barrier
    s_barrier
    s_barrier
    s_barrier
    s_barrier
    s_barrier
    s_barrier
    s_barrier
    s_mov_b32 s52, s42
    s_mov_b32 s53, s43
    s_mov_b32 s54, 13651968
    s_mov_b32 s55, 0x20000
    s_and_b32 s69, s3, 12
    s_add_u32 s69, s69, 163328
    v_mov_b32 v120, 163328
    v_mov_b32 v121, s69
    ds_read_b32 v120, v120 offset:224
    ds_read_b32 v121, v121 offset:228
    s_waitcnt lgkmcnt(0)
    v_readfirstlane_b32 s30, v120
    v_readfirstlane_b32 s70, v121
    s_nop 1
L_kgend_19:
    s_branch L_p1end_3
L_gate_dma:
    s_waitcnt lgkmcnt(0)
    s_mov_b32 s56, s36
    s_mov_b32 s57, s37
    s_mov_b32 s58, 1152
    s_mov_b32 s59, 0x20000
    v_lshlrev_b32 v4, 4, v1
    s_mov_b32 m0, 158720
    s_nop 0
    buffer_load_dwordx4 v4, s[56:59], 0 offen lds
    s_mov_b64 exec, 0xff
    buffer_load_dwordx4 v4, s[56:59], 0 offen offset:1024 lds
    s_mov_b64 exec, -1
    s_barrier
    s_waitcnt vmcnt(0)
L_gemm_2:
    v_mov_b32 v98, 163328
    v_mov_b32 v99, 1
    v_mov_b32 v104, 0
    v_mov_b32 v105, 0
    s_and_b32 s12, s3, 1
    s_and_b32 s13, s3, 2
    s_and_b32 s8, s3, 3
    s_cmp_ge_u32 s3, 12
    s_cselect_b32 s12, 2, s12
    s_cselect_b32 s13, s8, s13
    v_lshlrev_b32 v14, 4, v1
    s_waitcnt lgkmcnt(0)
    s_cmp_lg_u32 s3, 12
    s_cbranch_scc1 L_notouch_32
    s_and_b32 s8, s5, 7
    s_add_u32 s8, s8, 8
    s_sub_u32 s9, s8, 9
    s_cmp_ge_u32 s8, 9
    s_cselect_b32 s8, s9, s8
    s_lshl_b32 s8, s8, 2
    s_and_b32 s9, s4, 3
    s_add_u32 s8, s8, s9
    s_mul_i32 s8, s8, 55296
    s_mul_i32 s9, s5, 216
    s_add_u32 s8, s8, s9
    v_lshrrev_b32 v4, 2, v1
    v_mul_u32_u24 v4, 3456, v4
    v_and_b32 v5, 3, v1
    v_mul_u32_u24 v5, 68, v5
    v_add3_u32 v4, v4, v5, s8
    global_load_dword v96, v4, s[32:33]
    s_load_dword s60, s[42:43], 0
    s_lshr_b32 s69, s71, 1
    s_lshl_b32 s69, s69, 2
    s_load_dword s61, s[28:29], s69
    s_add_u32 s69, s69, 512
    s_load_dword s62, s[28:29], s69
    s_min_u32 s69, s68, 575
    s_lshr_b32 s69, s69, 1
    s_lshl_b32 s69, s69, 2
    s_load_dword s63, s[28:29], s69
    v_mov_b32 v20, 163328
    s_waitcnt lgkmcnt(0)
    s_mul_i32 s60, s60, 0x9e3779b1
    s_add_u32 s60, s60, 0x7f4a7c15
    v_mov_b32 v16, s60
    v_mov_b32 v17, s61
    v_mov_b32 v18, s62
    v_mov_b32 v19, s63
    ds_write_b128 v20, v[16:19] offset:224
    s_waitcnt lgkmcnt(0)
L_notouch_32:
    v_and_b32 v4, 31, v1
    v_lshrrev_b32 v5, 5, v1
    v_bfe_u32 v6, v1, 1, 3
    v_xor_b32 v6, v6, v5
    v_lshlrev_b32 v6, 4, v6
    v_lshl_add_u32 v6, v4, 7, v6
    s_lshl_b32 s7, s13, 12
    v_add_u32 v8, s7, v6
    v_lshlrev_b32 v100, 5, v4
    v_lshl_add_u32 v100, v5, 4, v100
    v_xor_b32 v9, 32, v8
    v_xor_b32 v10, 64, v8
    v_xor_b32 v11, 96, v8
    v_bfe_u32 v4, v1, 2, 2
    v_lshl_add_u32 v6, v5, 3, v4
    v_lshlrev_b32 v6, 8, v6
    v_xor_b32 v4, s12, v4
    v_lshl_add_u32 v6, v4, 6, v6
    v_and_b32 v4, 1, v1
    v_lshlrev_b32 v4, 4, v4
    v_and_b32 v7, 2, v1
    v_lshl_add_u32 v4, v7, 2, v4
    v_and_b32 v7, 16, v1
    v_lshl_add_u32 v4, v7, 1, v4
    v_add_u32 v12, v6, v4
    s_lshl2_add_u32 s10, s4, s13
    s_mul_i32 s15, s5, 3
    s_add_u32 s79, s15, s12
    s_lshr_b32 s74, s79, 4
    s_and_b32 s75, s79, 15
    s_lshl_b32 s75, s75, 1
    s_mov_b32 s77, 1051597459
    s_lshr_b32 s83, s10, 3
    s_mul_i32 s83, s83, 19456
    s_add_u32 s83, s83, 2560000
    s_mul_i32 s79, s75, 155648
    s_add_u32 s79, s79, s83
    s_and_b32 s80, s10, 7
    s_lshl_b32 s81, s80, 10
    s_add_u32 s81, s81, s79
    s_mul_i32 s80, s80, 1280
    s_add_u32 s80, s80, s79
    s_add_u32 s80, s80, 9216
    s_lshl_b32 s79, s75, 6
    s_add_u32 s79, s79, s10
    s_lshl_b32 s79, s79, 10
    s_add_u32 s79, s79, 200704
    s_mov_b32 s78, 155648
    s_cmp_eq_u32 s74, 0
    s_cselect_b32 s76, s79, s81
    s_cselect_b32 s78, 0x10000, s78
    s_movk_i32 s82, 1024
    s_cmp_eq_u32 s74, 2
    s_cselect_b32 s76, s80, s76
    s_cselect_b32 s82, 1280, s82
    s_cselect_b64 vcc, -1, 0
    v_cndmask_b32 v100, v14, v100, vcc
    s_lshl4_add_u32 s9, s5, s4
    s_lshl_b32 s9, s9, 7
    s_add_u32 s9, s9, 36864
    s_mov_b32 s52, s42
    s_mov_b32 s53, s43
    s_mov_b32 s54, 13651968
    s_mov_b32 s55, 0x20000
    s_cmp_lt_u32 s3, 12
    s_cbranch_scc1 L_nx_33
    v_lshrrev_b32 v4, 4, v1
    v_and_b32 v5, 15, v1
    v_bfe_u32 v6, v1, 1, 3
    v_xor_b32 v6, v6, v4
    v_lshlrev_b32 v6, 4, v6
    v_lshl_add_u32 v6, v5, 7, v6
    v_add_u32 v101, s7, v6
    v_xor_b32 v102, 64, v101
    v_bfe_u32 v6, v1, 2, 2
    v_lshl_add_u32 v7, v4, 3, v6
    v_lshlrev_b32 v7, 8, v7
    v_xor_b32 v6, 3, v6
    v_lshl_add_u32 v7, v6, 6, v7
    v_and_b32 v6, 3, v1
    v_lshl_add_u32 v7, v6, 4, v7
    v_add_u32 v6, 1, v6
    v_and_b32 v6, 4, v6
    v_lshl_add_u32 v103, v6, 16, v7
    v_lshlrev_b32 v13, 4, v4
    v_add_u32 v13, 158720, v13
    s_lshl_b32 s6, s11, 7
    v_add_u32 v97, s6, v13
    s_mov_b32 s72, 0xf000f000
    s_mov_b32 s73, 0xf000f000
    v_add_u32 v4, s15, v4
    v_cmp_gt_u32 s[44:45], 16, v4
    v_cmp_gt_u32 s[46:47], 32, v4
    v_and_b32 v4, 15, v4
    v_mov_b32 v106, s77
    v_cndmask_b32 v106, 1.0, v106, s[44:45]
    s_and_b32 s80, s10, 7
    s_lshl_b32 s81, s80, 7
    s_add_u32 s81, s81, 8192
    s_mul_i32 s80, s80, 1280
    s_add_u32 s80, s80, 10240
    v_lshl_add_u32 v6, v5, 2, s81
    v_and_b32 v7, 4, v1
    v_xor_b32 v7, 4, v7
    v_lshl_add_u32 v104, v7, 5, s80
    v_and_b32 v7, 8, v1
    v_lshl_add_u32 v104, v7, 2, v104
    v_and_b32 v7, 3, v1
    v_lshl_add_u32 v104, v7, 3, v104
    v_cndmask_b32 v104, v104, v6, s[46:47]
    v_mul_u32_u24 v6, 311296, v4
    v_add3_u32 v104, v104, v6, s83
    s_lshl_b32 s80, s10, 7
    s_add_u32 s80, s80, 2297856
    v_lshl_add_u32 v6, v4, 14, s80
    v_lshl_add_u32 v6, v5, 2, v6
    v_cndmask_b32 v104, v104, v6, s[44:45]
    v_mov_b32 v6, 155648
    v_mov_b32 v7, 0x2000
    v_cndmask_b32 v6, v6, v7, s[44:45]
    v_add_u32 v105, v104, v6
    s_andn2_b32 s48, -1, s46
    s_andn2_b32 s49, 0xffff, s47
    s_and_b32 s47, s47, 0xffff
L_nx_33:
    s_setprio 1
    s_cmp_ge_u32 s66, 576
    s_cbranch_scc1 L_noy_34
    s_mul_i32 s67, s65, 8704
    s_add_u32 s67, s67, 32768
    v_lshl_add_u32 v24, v1, 2, s67
    v_add_u32 v25, 1088, v24
    v_add_u32 v26, 2176, v24
    v_add_u32 v27, 3264, v24
    v_add_u32 v28, 4352, v24
    v_add_u32 v29, 5440, v24
    v_add_u32 v30, 6528, v24
    v_add_u32 v31, 7616, v24
    v_mov_b32 v35, 0x3c00
    s_lshl_b32 s67, s65, 2
    s_add_u32 s67, s67, 163328
    s_mov_b32 s60, 1069066811
    s_mov_b32 s61, 849703008
    s_mov_b32 s62, 1042479491
    s_mov_b32 s63, 836541576
    s_mov_b32 s64, 1060205080
    s_waitcnt vmcnt(0)
    v_lshlrev_b32 v123, 16, v123
    v_lshlrev_b32 v121, 16, v121
    v_mul_f32 v16, s60, v123
    v_mul_f32 v18, s60, v121
    v_fma_f32 v17, v123, s60, -v16
    v_fma_f32 v19, v121, s60, -v18
    v_exp_f32 v16, v16
    v_exp_f32 v18, v18
    v_fma_f32 v17, v123, s61, v17
    v_fma_f32 v19, v121, s61, v19
    v_mul_f32 v17, s64, v17
    v_mul_f32 v19, s64, v19
    v_fma_f32 v123, v16, v17, v16
    v_fma_f32 v121, v18, v19, v18
    v_cvt_pk_bf16_f32 v123, v123, v123
    v_cvt_pk_bf16_f32 v121, v121, v121
    v_and_b32 v123, 0xffff0000, v123
    v_and_b32 v121, 0xffff0000, v121
    v_lshlrev_b32 v122, 16, v122
    v_mul_f32 v121, v121, v123
    v_mul_f32 v122, v122, v123
    v_mul_f32 v32, s60, -v121
    v_mul_f32 v33, s62, v122
    v_fma_f32 v34, v122, s62, -v33
    v_fma_f32 v34, v122, s63, v34
    v_mul_f32 v16, 1090519040, v33
    v_mul_f32 v18, 1115684864, v33
    v_mul_f32 v17, 1090519040, v32
    v_mul_f32 v19, 1115684864, v32
    v_fract_f32 v16, v16
    v_fract_f32 v18, v18
    v_exp_f32 v17, v17
    v_exp_f32 v19, v19
    v_fmac_f32 v16, 1090519040, v34
    v_fmac_f32 v18, 1115684864, v34
    v_cos_f32 v46, v16
    v_cos_f32 v54, v18
    v_sin_f32 v47, v16
    v_sin_f32 v55, v18
    v_mul_f32 v46, v46, v17
    v_mul_f32 v54, v54, v19
    v_mul_f32 v47, v47, v17
    v_mul_f32 v55, v55, v19
    v_mul_f32 v48, v47, v47
    v_mul_f32 v58, v55, v55
    v_mul_f32 v49, v47, v46
    v_mul_f32 v59, v55, v54
    v_fma_f32 v48, v46, v46, -v48
    v_fma_f32 v58, v54, v54, -v58
    v_fmac_f32 v49, v46, v47
    v_fmac_f32 v59, v54, v55
    v_mul_f32 v52, v49, v49
    v_mul_f32 v50, v47, v49
    v_mul_f32 v62, v59, v55
    v_mul_f32 v53, v49, v48
    v_mul_f32 v51, v47, v48
    v_mul_f32 v63, v59, v54
    v_fma_f32 v52, v48, v48, -v52
    v_fma_f32 v50, v46, v48, -v50
    v_fma_f32 v62, v58, v54, -v62
    v_fmac_f32 v53, v48, v49
    v_fmac_f32 v51, v46, v49
    v_fmac_f32 v63, v58, v55
    v_mul_f32 v56, v53, v55
    v_mul_f32 v60, v59, v53
    v_mul_f32 v64, v63, v53
    v_mul_f32 v57, v53, v54
    v_mul_f32 v61, v59, v52
    v_mul_f32 v65, v63, v52
    v_fma_f32 v56, v52, v54, -v56
    v_fma_f32 v60, v58, v52, -v60
    v_fma_f32 v64, v62, v52, -v64
    v_fmac_f32 v57, v52, v55
    v_fmac_f32 v61, v58, v53
    v_fmac_f32 v65, v62, v53
    v_cvt_pk_f16_f32 v36, v46, -v47
    v_cvt_pk_f16_f32 v37, v48, -v49
    v_cvt_pk_f16_f32 v38, v50, -v51
    v_cvt_pk_f16_f32 v39, v52, -v53
    v_cvt_pk_f16_f32 v40, v54, -v55
    v_cvt_pk_f16_f32 v41, v56, -v57
    v_cvt_pk_f16_f32 v42, v58, -v59
    v_cvt_pk_f16_f32 v43, v60, -v61
    v_cvt_pk_f16_f32 v44, v62, -v63
    v_cvt_pk_f16_f32 v45, v64, -v65
    ds_write2_b32 v24, v35, v36 offset0:0 offset1:68
    ds_write2_b32 v24, v37, v38 offset0:136 offset1:204
    v_pk_mul_f16 v21, v36, v39 op_sel:[0,0] op_sel_hi:[0,1]
    v_pk_mul_f16 v22, v37, v39 op_sel:[0,0] op_sel_hi:[0,1]
    v_pk_mul_f16 v23, v38, v39 op_sel:[0,0] op_sel_hi:[0,1]
    v_pk_fma_f16 v21, v36, v39, v21 op_sel:[1,1,0] op_sel_hi:[1,0,1] neg_lo:[1,0,0]
    v_pk_fma_f16 v22, v37, v39, v22 op_sel:[1,1,0] op_sel_hi:[1,0,1] neg_lo:[1,0,0]
    v_pk_fma_f16 v23, v38, v39, v23 op_sel:[1,1,0] op_sel_hi:[1,0,1] neg_lo:[1,0,0]
    ds_write2_b32 v25, v39, v21 offset0:0 offset1:68
    ds_write2_b32 v25, v22, v23 offset0:136 offset1:204
    v_pk_mul_f16 v17, v36, v40 op_sel:[0,0] op_sel_hi:[0,1]
    v_pk_mul_f16 v18, v37, v40 op_sel:[0,0] op_sel_hi:[0,1]
    v_pk_mul_f16 v19, v38, v40 op_sel:[0,0] op_sel_hi:[0,1]
    v_pk_fma_f16 v17, v36, v40, v17 op_sel:[1,1,0] op_sel_hi:[1,0,1] neg_lo:[1,0,0]
    v_pk_fma_f16 v18, v37, v40, v18 op_sel:[1,1,0] op_sel_hi:[1,0,1] neg_lo:[1,0,0]
    v_pk_fma_f16 v19, v38, v40, v19 op_sel:[1,1,0] op_sel_hi:[1,0,1] neg_lo:[1,0,0]
    ds_write2_b32 v26, v40, v17 offset0:0 offset1:68
    ds_write2_b32 v26, v18, v19 offset0:136 offset1:204
    v_pk_mul_f16 v21, v36, v41 op_sel:[0,0] op_sel_hi:[0,1]
    v_pk_mul_f16 v22, v37, v41 op_sel:[0,0] op_sel_hi:[0,1]
    v_pk_mul_f16 v23, v38, v41 op_sel:[0,0] op_sel_hi:[0,1]
    v_pk_fma_f16 v21, v36, v41, v21 op_sel:[1,1,0] op_sel_hi:[1,0,1] neg_lo:[1,0,0]
    v_pk_fma_f16 v22, v37, v41, v22 op_sel:[1,1,0] op_sel_hi:[1,0,1] neg_lo:[1,0,0]
    v_pk_fma_f16 v23, v38, v41, v23 op_sel:[1,1,0] op_sel_hi:[1,0,1] neg_lo:[1,0,0]
    ds_write2_b32 v27, v41, v21 offset0:0 offset1:68
    ds_write2_b32 v27, v22, v23 offset0:136 offset1:204
    v_pk_mul_f16 v17, v36, v42 op_sel:[0,0] op_sel_hi:[0,1]
    v_pk_mul_f16 v18, v37, v42 op_sel:[0,0] op_sel_hi:[0,1]
    v_pk_mul_f16 v19, v38, v42 op_sel:[0,0] op_sel_hi:[0,1]
    v_pk_fma_f16 v17, v36, v42, v17 op_sel:[1,1,0] op_sel_hi:[1,0,1] neg_lo:[1,0,0]
    v_pk_fma_f16 v18, v37, v42, v18 op_sel:[1,1,0] op_sel_hi:[1,0,1] neg_lo:[1,0,0]
    v_pk_fma_f16 v19, v38, v42, v19 op_sel:[1,1,0] op_sel_hi:[1,0,1] neg_lo:[1,0,0]
    ds_write2_b32 v28, v42, v17 offset0:0 offset1:68
    ds_write2_b32 v28, v18, v19 offset0:136 offset1:204
    v_pk_mul_f16 v21, v36, v43 op_sel:[0,0] op_sel_hi:[0,1]
    v_pk_mul_f16 v22, v37, v43 op_sel:[0,0] op_sel_hi:[0,1]
    v_pk_mul_f16 v23, v38, v43 op_sel:[0,0] op_sel_hi:[0,1]
    v_pk_fma_f16 v21, v36, v43, v21 op_sel:[1,1,0] op_sel_hi:[1,0,1] neg_lo:[1,0,0]
    v_pk_fma_f16 v22, v37, v43, v22 op_sel:[1,1,0] op_sel_hi:[1,0,1] neg_lo:[1,0,0]
    v_pk_fma_f16 v23, v38, v43, v23 op_sel:[1,1,0] op_sel_hi:[1,0,1] neg_lo:[1,0,0]
    ds_write2_b32 v29, v43, v21 offset0:0 offset1:68
    ds_write2_b32 v29, v22, v23 offset0:136 offset1:204
    v_pk_mul_f16 v17, v36, v44 op_sel:[0,0] op_sel_hi:[0,1]
    v_pk_mul_f16 v18, v37, v44 op_sel:[0,0] op_sel_hi:[0,1]
    v_pk_mul_f16 v19, v38, v44 op_sel:[0,0] op_sel_hi:[0,1]
    v_pk_fma_f16 v17, v36, v44, v17 op_sel:[1,1,0] op_sel_hi:[1,0,1] neg_lo:[1,0,0]
    v_pk_fma_f16 v18, v37, v44, v18 op_sel:[1,1,0] op_sel_hi:[1,0,1] neg_lo:[1,0,0]
    v_pk_fma_f16 v19, v38, v44, v19 op_sel:[1,1,0] op_sel_hi:[1,0,1] neg_lo:[1,0,0]
    ds_write2_b32 v30, v44, v17 offset0:0 offset1:68
    ds_write2_b32 v30, v18, v19 offset0:136 offset1:204
    v_pk_mul_f16 v21, v36, v45 op_sel:[0,0] op_sel_hi:[0,1]
    v_pk_mul_f16 v22, v37, v45 op_sel:[0,0] op_sel_hi:[0,1]
    v_pk_mul_f16 v23, v38, v45 op_sel:[0,0] op_sel_hi:[0,1]
    v_pk_fma_f16 v21, v36, v45, v21 op_sel:[1,1,0] op_sel_hi:[1,0,1] neg_lo:[1,0,0]
    v_pk_fma_f16 v22, v37, v45, v22 op_sel:[1,1,0] op_sel_hi:[1,0,1] neg_lo:[1,0,0]
    v_pk_fma_f16 v23, v38, v45, v23 op_sel:[1,1,0] op_sel_hi:[1,0,1] neg_lo:[1,0,0]
    ds_write2_b32 v31, v45, v21 offset0:0 offset1:68
    ds_write2_b32 v31, v22, v23 offset0:136 offset1:204
    v_mov_b32 v16, s67
    v_mov_b32 v17, 1
    s_mov_b64 exec, 1
    ds_add_u32 v16, v17 offset:160
    s_mov_b64 exec, -1
L_noy_34:
    s_setprio 3
    v_mov_b32 v64, 0
    v_mov_b32 v65, 0
    v_mov_b32 v66, 0
    v_mov_b32 v67, 0
    v_mov_b32 v68, 0
    v_mov_b32 v69, 0
    v_mov_b32 v70, 0
    v_mov_b32 v71, 0
    v_mov_b32 v72, 0
    v_mov_b32 v73, 0
    v_mov_b32 v74, 0
    v_mov_b32 v75, 0
    v_mov_b32 v76, 0
    v_mov_b32 v77, 0
    v_mov_b32 v78, 0
    v_mov_b32 v79, 0
    v_mov_b32 v80, 0
    v_mov_b32 v81, 0
    v_mov_b32 v82, 0
    v_mov_b32 v83, 0
    v_mov_b32 v84, 0
    v_mov_b32 v85, 0
    v_mov_b32 v86, 0
    v_mov_b32 v87, 0
    v_mov_b32 v88, 0
    v_mov_b32 v89, 0
    v_mov_b32 v90, 0
    v_mov_b32 v91, 0
    v_mov_b32 v92, 0
    v_mov_b32 v93, 0
    v_mov_b32 v94, 0
    v_mov_b32 v95, 0
    s_mov_b32 s14, 1
    s_mov_b32 s8, 0x18000
    s_mov_b32 s7, 0x8000
    s_cmp_ge_u32 s3, 12
    s_cbranch_scc1 L_young_35
    s_barrier
    ds_read_b64_tr_b16 v[48:49], v12 offset:16384
    ds_read_b64_tr_b16 v[50:51], v12 offset:17408
    ds_read_b128 v[16:19], v8
    ds_read_b128 v[20:23], v8 offset:4096
    ds_read_b64_tr_b16 v[52:53], v12 offset:20480
    ds_read_b64_tr_b16 v[54:55], v12 offset:21504
    ds_read_b128 v[24:27], v9
    ds_read_b128 v[28:31], v9 offset:4096
    v_xor_b32 v8, s8, v8
    .p2align 3
L_gloop_41:
    s_waitcnt lgkmcnt(4)
    v_mfma_f32_32x32x16_bf16 v[64:79], v[48:51], v[16:19], v[64:79]
    ds_read_b64_tr_b16 v[56:57], v12 offset:24576
    ds_read_b64_tr_b16 v[58:59], v12 offset:25600
    v_mfma_f32_32x32x16_bf16 v[80:95], v[48:51], v[20:23], v[80:95]
    ds_read_b128 v[32:35], v10
    ds_read_b128 v[36:39], v10 offset:4096
    v_xor_b32 v9, s8, v9
    s_waitcnt lgkmcnt(4)
    v_mfma_f32_32x32x16_bf16 v[64:79], v[52:55], v[24:27], v[64:79]
    ds_read_b64_tr_b16 v[60:61], v12 offset:28672
    ds_read_b64_tr_b16 v[62:63], v12 offset:29696
    v_mfma_f32_32x32x16_bf16 v[80:95], v[52:55], v[28:31], v[80:95]
    ds_read_b128 v[40:43], v11
    ds_read_b128 v[44:47], v11 offset:4096
    v_xor_b32 v10, s8, v10
    s_waitcnt lgkmcnt(4)
    v_mfma_f32_32x32x16_bf16 v[64:79], v[56:59], v[32:35], v[64:79]
    v_xor_b32 v12, s8, v12
    s_barrier
    ds_read_b64_tr_b16 v[48:49], v12 offset:16384
    ds_read_b64_tr_b16 v[50:51], v12 offset:17408
    v_mfma_f32_32x32x16_bf16 v[80:95], v[56:59], v[36:39], v[80:95]
    ds_read_b128 v[16:19], v8
    ds_read_b128 v[20:23], v8 offset:4096
    v_xor_b32 v11, s8, v11
    s_waitcnt lgkmcnt(4)
    v_mfma_f32_32x32x16_bf16 v[64:79], v[60:63], v[40:43], v[64:79]
    ds_read_b64_tr_b16 v[52:53], v12 offset:20480
    ds_read_b64_tr_b16 v[54:55], v12 offset:21504
    v_mfma_f32_32x32x16_bf16 v[80:95], v[60:63], v[44:47], v[80:95]
    ds_read_b128 v[24:27], v9
    ds_read_b128 v[28:31], v9 offset:4096
    v_xor_b32 v8, s7, v8
    s_add_u32 s14, s14, 1
    s_xor_b32 s8, s8, 0x10000
    s_xor_b32 s7, s7, 0x10000
    s_cmp_lt_u32 s14, 9
    s_cbranch_scc1 L_gloop_41
    s_waitcnt lgkmcnt(4)
    v_mfma_f32_32x32x16_bf16 v[64:79], v[48:51], v[16:19], v[64:79]
    ds_read_b64_tr_b16 v[56:57], v12 offset:24576
    ds_read_b64_tr_b16 v[58:59], v12 offset:25600
    v_mfma_f32_32x32x16_bf16 v[80:95], v[48:51], v[20:23], v[80:95]
    ds_read_b128 v[32:35], v10
    ds_read_b128 v[36:39], v10 offset:4096
    s_waitcnt lgkmcnt(4)
    v_mfma_f32_32x32x16_bf16 v[64:79], v[52:55], v[24:27], v[64:79]
    ds_read_b64_tr_b16 v[60:61], v12 offset:28672
    ds_read_b64_tr_b16 v[62:63], v12 offset:29696
    v_mfma_f32_32x32x16_bf16 v[80:95], v[52:55], v[28:31], v[80:95]
    ds_read_b128 v[40:43], v11
    ds_read_b128 v[44:47], v11 offset:4096
    s_waitcnt lgkmcnt(4)
    v_mfma_f32_32x32x16_bf16 v[64:79], v[56:59], v[32:35], v[64:79]
    v_mfma_f32_32x32x16_bf16 v[80:95], v[56:59], v[36:39], v[80:95]
    s_waitcnt lgkmcnt(0)
    v_mfma_f32_32x32x16_bf16 v[64:79], v[60:63], v[40:43], v[64:79]
    v_mfma_f32_32x32x16_bf16 v[80:95], v[60:63], v[44:47], v[80:95]
    s_nop 9
    s_cmp_lg_u32 s74, 0
    s_cbranch_scc1 L_noscale_42
    v_mul_f32 v64, s77, v64
    v_mul_f32 v65, s77, v65
    v_mul_f32 v66, s77, v66
    v_mul_f32 v67, s77, v67
    v_mul_f32 v68, s77, v68
    v_mul_f32 v69, s77, v69
    v_mul_f32 v70, s77, v70
    v_mul_f32 v71, s77, v71
    v_mul_f32 v72, s77, v72
    v_mul_f32 v73, s77, v73
    v_mul_f32 v74, s77, v74
    v_mul_f32 v75, s77, v75
    v_mul_f32 v76, s77, v76
    v_mul_f32 v77, s77, v77
    v_mul_f32 v78, s77, v78
    v_mul_f32 v79, s77, v79
    v_mul_f32 v80, s77, v80
    v_mul_f32 v81, s77, v81
    v_mul_f32 v82, s77, v82
    v_mul_f32 v83, s77, v83
    v_mul_f32 v84, s77, v84
    v_mul_f32 v85, s77, v85
    v_mul_f32 v86, s77, v86
    v_mul_f32 v87, s77, v87
    v_mul_f32 v88, s77, v88
    v_mul_f32 v89, s77, v89
    v_mul_f32 v90, s77, v90
    v_mul_f32 v91, s77, v91
    v_mul_f32 v92, s77, v92
    v_mul_f32 v93, s77, v93
    v_mul_f32 v94, s77, v94
    v_mul_f32 v95, s77, v95
L_noscale_42:
    v_cvt_pk_bf16_f32 v16, v64, v65
    v_cvt_pk_bf16_f32 v17, v66, v67
    v_cvt_pk_bf16_f32 v18, v68, v69
    v_cvt_pk_bf16_f32 v19, v70, v71
    buffer_store_dwordx4 v[16:19], v100, s[52:55], s76 offen sc1
    v_cvt_pk_bf16_f32 v20, v72, v73
    v_cvt_pk_bf16_f32 v21, v74, v75
    v_cvt_pk_bf16_f32 v22, v76, v77
    v_cvt_pk_bf16_f32 v23, v78, v79
    s_add_u32 s79, s76, s78
    buffer_store_dwordx4 v[20:23], v100, s[52:55], s79 offen sc1
    s_add_u32 s76, s76, s82
    v_cvt_pk_bf16_f32 v24, v80, v81
    v_cvt_pk_bf16_f32 v25, v82, v83
    v_cvt_pk_bf16_f32 v26, v84, v85
    v_cvt_pk_bf16_f32 v27, v86, v87
    buffer_store_dwordx4 v[24:27], v100, s[52:55], s76 offen sc1
    v_cvt_pk_bf16_f32 v28, v88, v89
    v_cvt_pk_bf16_f32 v29, v90, v91
    v_cvt_pk_bf16_f32 v30, v92, v93
    v_cvt_pk_bf16_f32 v31, v94, v95
    s_add_u32 s79, s76, s78
    buffer_store_dwordx4 v[28:31], v100, s[52:55], s79 offen sc1
    s_branch L_gdone_38
L_gatel_36:
    s_barrier
    ds_read_b64_tr_b16 v[48:49], v12 offset:16384
    ds_read_b64_tr_b16 v[50:51], v12 offset:17408
    ds_read_b128 v[16:19], v8
    ds_read_b128 v[20:23], v101 offset:0
    ds_read_b64_tr_b16 v[88:89], v103 offset:16384
    ds_read_b64_tr_b16 v[90:91], v103 offset:17408
    s_mov_b64 exec, s[72:73]
    ds_read_b128 v[88:91], v97 offset:0
    s_mov_b64 exec, -1
    ds_read_b64_tr_b16 v[52:53], v12 offset:20480
    ds_read_b64_tr_b16 v[54:55], v12 offset:21504
    ds_read_b128 v[24:27], v9
    ds_read_b128 v[28:31], v101 offset:2048
    v_xor_b32 v8, s8, v8
    .p2align 3
L_gloop_43:
    s_waitcnt lgkmcnt(4)
    v_mfma_f32_32x32x16_bf16 v[64:79], v[48:51], v[16:19], v[64:79]
    s_add_u32 s6, s6, 128
    s_cmp_eq_u32 s6, 1152
    s_cselect_b32 s6, 0, s6
    ds_read_b64_tr_b16 v[56:57], v12 offset:24576
    ds_read_b64_tr_b16 v[58:59], v12 offset:25600
    ds_read_b128 v[32:35], v10
    ds_read_b128 v[36:39], v102 offset:0
    ds_read_b64_tr_b16 v[92:93], v103 offset:24576
    ds_read_b64_tr_b16 v[94:95], v103 offset:25600
    s_mov_b64 exec, s[72:73]
    ds_read_b128 v[92:95], v97 offset:64
    s_mov_b64 exec, -1
    v_xor_b32 v9, s8, v9
    s_waitcnt lgkmcnt(7)
    v_mfma_f32_32x32x16_bf16 v[64:79], v[52:55], v[24:27], v[64:79]
    v_xor_b32 v101, s8, v101
    v_xor_b32 v103, s8, v103
    ds_read_b64_tr_b16 v[60:61], v12 offset:28672
    ds_read_b64_tr_b16 v[62:63], v12 offset:29696
    v_mfma_f32_16x16x32_bf16 v[80:83], v[88:91], v[20:23], v[80:83]
    v_mfma_f32_16x16x32_bf16 v[84:87], v[88:91], v[28:31], v[84:87]
    ds_read_b128 v[40:43], v11
    ds_read_b128 v[44:47], v102 offset:2048
    v_xor_b32 v10, s8, v10
    s_waitcnt lgkmcnt(4)
    v_mfma_f32_32x32x16_bf16 v[64:79], v[56:59], v[32:35], v[64:79]
    v_xor_b32 v12, s8, v12
    v_add_u32 v97, s6, v13
    s_barrier
    ds_read_b64_tr_b16 v[48:49], v12 offset:16384
    ds_read_b64_tr_b16 v[50:51], v12 offset:17408
    ds_read_b128 v[16:19], v8
    ds_read_b128 v[20:23], v101 offset:0
    ds_read_b64_tr_b16 v[88:89], v103 offset:16384
    ds_read_b64_tr_b16 v[90:91], v103 offset:17408
    s_mov_b64 exec, s[72:73]
    ds_read_b128 v[88:91], v97 offset:0
    s_mov_b64 exec, -1
    v_xor_b32 v11, s8, v11
    s_waitcnt lgkmcnt(7)
    v_mfma_f32_32x32x16_bf16 v[64:79], v[60:63], v[40:43], v[64:79]
    v_xor_b32 v102, s8, v102
    ds_read_b64_tr_b16 v[52:53], v12 offset:20480
    ds_read_b64_tr_b16 v[54:55], v12 offset:21504
    v_mfma_f32_16x16x32_bf16 v[80:83], v[92:95], v[36:39], v[80:83]
    v_mfma_f32_16x16x32_bf16 v[84:87], v[92:95], v[44:47], v[84:87]
    ds_read_b128 v[24:27], v9
    ds_read_b128 v[28:31], v101 offset:2048
    v_xor_b32 v8, s7, v8
    s_add_u32 s14, s14, 1
    s_xor_b32 s8, s8, 0x10000
    s_xor_b32 s7, s7, 0x10000
    s_cmp_lt_u32 s14, 9
    s_cbranch_scc1 L_gloop_43
    s_waitcnt lgkmcnt(4)
    v_mfma_f32_32x32x16_bf16 v[64:79], v[48:51], v[16:19], v[64:79]
    ds_read_b64_tr_b16 v[56:57], v12 offset:24576
    ds_read_b64_tr_b16 v[58:59], v12 offset:25600
    ds_read_b128 v[32:35], v10
    ds_read_b128 v[36:39], v102 offset:0
    ds_read_b64_tr_b16 v[92:93], v103 offset:24576
    ds_read_b64_tr_b16 v[94:95], v103 offset:25600
    s_mov_b64 exec, s[72:73]
    ds_read_b128 v[92:95], v97 offset:64
    s_mov_b64 exec, -1
    s_waitcnt lgkmcnt(7)
    v_mfma_f32_32x32x16_bf16 v[64:79], v[52:55], v[24:27], v[64:79]
    ds_read_b64_tr_b16 v[60:61], v12 offset:28672
    ds_read_b64_tr_b16 v[62:63], v12 offset:29696
    v_mfma_f32_16x16x32_bf16 v[80:83], v[88:91], v[20:23], v[80:83]
    v_mfma_f32_16x16x32_bf16 v[84:87], v[88:91], v[28:31], v[84:87]
    ds_read_b128 v[40:43], v11
    ds_read_b128 v[44:47], v102 offset:2048
    s_waitcnt lgkmcnt(4)
    v_mfma_f32_32x32x16_bf16 v[64:79], v[56:59], v[32:35], v[64:79]
    s_waitcnt lgkmcnt(0)
    v_mfma_f32_32x32x16_bf16 v[64:79], v[60:63], v[40:43], v[64:79]
    v_mfma_f32_16x16x32_bf16 v[80:83], v[92:95], v[36:39], v[80:83]
    v_mfma_f32_16x16x32_bf16 v[84:87], v[92:95], v[44:47], v[84:87]
    s_branch L_gj_37
L_young_35:
    s_cmp_eq_u32 s5, 0
    s_cbranch_scc1 L_gatel_36
    s_barrier
    ds_read_b64_tr_b16 v[48:49], v12 offset:16384
    ds_read_b64_tr_b16 v[50:51], v12 offset:17408
    ds_read_b128 v[16:19], v8
    ds_read_b128 v[20:23], v101 offset:0
    ds_read_b64_tr_b16 v[88:89], v103 offset:16384
    ds_read_b64_tr_b16 v[90:91], v103 offset:17408
    ds_read_b64_tr_b16 v[52:53], v12 offset:20480
    ds_read_b64_tr_b16 v[54:55], v12 offset:21504
    ds_read_b128 v[24:27], v9
    ds_read_b128 v[28:31], v101 offset:2048
    v_xor_b32 v8, s8, v8
    .p2align 3
L_gloop_44:
    s_waitcnt lgkmcnt(4)
    v_mfma_f32_32x32x16_bf16 v[64:79], v[48:51], v[16:19], v[64:79]
    ds_read_b64_tr_b16 v[56:57], v12 offset:24576
    ds_read_b64_tr_b16 v[58:59], v12 offset:25600
    ds_read_b128 v[32:35], v10
    ds_read_b128 v[36:39], v102 offset:0
    ds_read_b64_tr_b16 v[92:93], v103 offset:24576
    ds_read_b64_tr_b16 v[94:95], v103 offset:25600
    v_xor_b32 v9, s8, v9
    s_waitcnt lgkmcnt(6)
    v_mfma_f32_32x32x16_bf16 v[64:79], v[52:55], v[24:27], v[64:79]
    v_xor_b32 v101, s8, v101
    v_xor_b32 v103, s8, v103
    ds_read_b64_tr_b16 v[60:61], v12 offset:28672
    ds_read_b64_tr_b16 v[62:63], v12 offset:29696
    v_mfma_f32_16x16x32_bf16 v[80:83], v[88:91], v[20:23], v[80:83]
    v_mfma_f32_16x16x32_bf16 v[84:87], v[88:91], v[28:31], v[84:87]
    ds_read_b128 v[40:43], v11
    ds_read_b128 v[44:47], v102 offset:2048
    v_xor_b32 v10, s8, v10
    s_waitcnt lgkmcnt(4)
    v_mfma_f32_32x32x16_bf16 v[64:79], v[56:59], v[32:35], v[64:79]
    v_xor_b32 v12, s8, v12
    s_barrier
    ds_read_b64_tr_b16 v[48:49], v12 offset:16384
    ds_read_b64_tr_b16 v[50:51], v12 offset:17408
    ds_read_b128 v[16:19], v8
    ds_read_b128 v[20:23], v101 offset:0
    ds_read_b64_tr_b16 v[88:89], v103 offset:16384
    ds_read_b64_tr_b16 v[90:91], v103 offset:17408
    v_xor_b32 v11, s8, v11
    s_waitcnt lgkmcnt(6)
    v_mfma_f32_32x32x16_bf16 v[64:79], v[60:63], v[40:43], v[64:79]
    v_xor_b32 v102, s8, v102
    ds_read_b64_tr_b16 v[52:53], v12 offset:20480
    ds_read_b64_tr_b16 v[54:55], v12 offset:21504
    v_mfma_f32_16x16x32_bf16 v[80:83], v[92:95], v[36:39], v[80:83]
    v_mfma_f32_16x16x32_bf16 v[84:87], v[92:95], v[44:47], v[84:87]
    ds_read_b128 v[24:27], v9
    ds_read_b128 v[28:31], v101 offset:2048
    v_xor_b32 v8, s7, v8
    s_add_u32 s14, s14, 1
    s_xor_b32 s8, s8, 0x10000
    s_xor_b32 s7, s7, 0x10000
    s_cmp_lt_u32 s14, 9
    s_cbranch_scc1 L_gloop_44
    s_waitcnt lgkmcnt(4)
    v_mfma_f32_32x32x16_bf16 v[64:79], v[48:51], v[16:19], v[64:79]
    ds_read_b64_tr_b16 v[56:57], v12 offset:24576
    ds_read_b64_tr_b16 v[58:59], v12 offset:25600
    ds_read_b128 v[32:35], v10
    ds_read_b128 v[36:39], v102 offset:0
    ds_read_b64_tr_b16 v[92:93], v103 offset:24576
    ds_read_b64_tr_b16 v[94:95], v103 offset:25600
    s_waitcnt lgkmcnt(6)
    v_mfma_f32_32x32x16_bf16 v[64:79], v[52:55], v[24:27], v[64:79]
    ds_read_b64_tr_b16 v[60:61], v12 offset:28672
    ds_read_b64_tr_b16 v[62:63], v12 offset:29696
    v_mfma_f32_16x16x32_bf16 v[80:83], v[88:91], v[20:23], v[80:83]
    v_mfma_f32_16x16x32_bf16 v[84:87], v[88:91], v[28:31], v[84:87]
    ds_read_b128 v[40:43], v11
    ds_read_b128 v[44:47], v102 offset:2048
    s_waitcnt lgkmcnt(4)
    v_mfma_f32_32x32x16_bf16 v[64:79], v[56:59], v[32:35], v[64:79]
    s_waitcnt lgkmcnt(0)
    v_mfma_f32_32x32x16_bf16 v[64:79], v[60:63], v[40:43], v[64:79]
    v_mfma_f32_16x16x32_bf16 v[80:83], v[92:95], v[36:39], v[80:83]
    v_mfma_f32_16x16x32_bf16 v[84:87], v[92:95], v[44:47], v[84:87]
L_gj_37:
    s_nop 9
    s_cmp_lg_u32 s74, 0
    s_cbranch_scc1 L_noscale_45
    v_mul_f32 v64, s77, v64
    v_mul_f32 v65, s77, v65
    v_mul_f32 v66, s77, v66
    v_mul_f32 v67, s77, v67
    v_mul_f32 v68, s77, v68
    v_mul_f32 v69, s77, v69
    v_mul_f32 v70, s77, v70
    v_mul_f32 v71, s77, v71
    v_mul_f32 v72, s77, v72
    v_mul_f32 v73, s77, v73
    v_mul_f32 v74, s77, v74
    v_mul_f32 v75, s77, v75
    v_mul_f32 v76, s77, v76
    v_mul_f32 v77, s77, v77
    v_mul_f32 v78, s77, v78
    v_mul_f32 v79, s77, v79
L_noscale_45:
    v_cvt_pk_bf16_f32 v16, v64, v65
    v_cvt_pk_bf16_f32 v17, v66, v67
    v_cvt_pk_bf16_f32 v18, v68, v69
    v_cvt_pk_bf16_f32 v19, v70, v71
    buffer_store_dwordx4 v[16:19], v100, s[52:55], s76 offen sc1
    v_cvt_pk_bf16_f32 v20, v72, v73
    v_cvt_pk_bf16_f32 v21, v74, v75
    v_cvt_pk_bf16_f32 v22, v76, v77
    v_cvt_pk_bf16_f32 v23, v78, v79
    s_add_u32 s79, s76, s78
    buffer_store_dwordx4 v[20:23], v100, s[52:55], s79 offen sc1
    v_mov_b32 v4, v80
    v_mov_b32 v5, v84
    v_mul_f32 v80, v106, v80
    v_mul_f32 v81, v106, v81
    v_mul_f32 v82, v106, v82
    v_mul_f32 v83, v106, v83
    v_mul_f32 v84, v106, v84
    v_mul_f32 v85, v106, v85
    v_mul_f32 v86, v106, v86
    v_mul_f32 v87, v106, v87
    v_cvt_pk_bf16_f32 v24, v80, v81
    v_mov_b32 v25, 0x3f80
    v_cvt_pk_bf16_f32 v26, v82, v83
    v_mov_b32 v27, 0x3f80
    v_cvt_pk_bf16_f32 v28, v84, v85
    v_mov_b32 v29, 0x3f80
    v_cvt_pk_bf16_f32 v30, v86, v87
    v_mov_b32 v31, 0x3f80
    s_cmp_eq_u64 s[46:47], 0
    s_cbranch_scc1 L_xv_39
    s_mov_b64 exec, s[46:47]
    buffer_store_dword v24, v104, s[52:55], 0 offen offset:0 sc1
    buffer_store_dword v26, v105, s[52:55], 0 offen offset:0 sc1
    buffer_store_dword v28, v104, s[52:55], 0 offen offset:64 sc1
    buffer_store_dword v30, v105, s[52:55], 0 offen offset:64 sc1
L_xv_39:
    s_cmp_eq_u64 s[48:49], 0
    s_cbranch_scc1 L_xg_40
    s_mov_b64 exec, s[48:49]
    buffer_store_dwordx2 v[24:25], v104, s[52:55], 0 offen offset:0 sc1
    buffer_store_dwordx2 v[26:27], v105, s[52:55], 0 offen offset:0 sc1
    buffer_store_dwordx2 v[28:29], v104, s[52:55], 0 offen offset:64 sc1
    buffer_store_dwordx2 v[30:31], v105, s[52:55], 0 offen offset:64 sc1
L_xg_40:
    s_mov_b64 exec, -1
    s_cmp_lg_u32 s5, 0
    s_cbranch_scc1 L_gdone_38
    v_lshlrev_b32 v6, 2, v1
    s_lshl_b32 s79, s10, 7
    s_add_u32 s79, s79, 12922688
    s_mov_b32 exec_lo, 0
    s_mov_b32 exec_hi, 0xffff0000
    buffer_store_dword v4, v6, s[52:55], s79 offen sc1
    buffer_store_dword v5, v6, s[52:55], s79 offen offset:64 sc1
L_gdone_38:
    s_mov_b64 exec, 1
    ds_add_u32 v98, v99 offset:144
    s_mov_b64 exec, -1
    s_and_b32 s69, s3, 12
    s_add_u32 s69, s69, 163328
    v_mov_b32 v6, 163328
    v_mov_b32 v7, s69
    ds_read_b32 v6, v6 offset:224
    ds_read_b32 v7, v7 offset:228
    s_waitcnt lgkmcnt(0)
    v_readfirstlane_b32 s30, v6
    v_readfirstlane_b32 s70, v7
    s_nop 1
    s_mov_b32 s67, s9
    s_waitcnt vmcnt(0)
    v_mov_b32 v6, 163328
    v_mov_b32 v7, 1
    s_mov_b64 exec, 1
    ds_add_rtn_u32 v7, v6, v7 offset:64
    s_mov_b64 exec, -1
    s_waitcnt lgkmcnt(0)
    v_readfirstlane_b32 s8, v7
    s_cmp_lg_u32 s8, 7
    s_cbranch_scc1 L_nofq_46
    v_mov_b32 v6, s30
    v_lshlrev_b32 v7, 2, v1
    s_mov_b64 exec, 0xffff
    buffer_store_dword v6, v7, s[52:55], s67 offen sc1
    s_mov_b64 exec, -1
L_nofq_46:
L_p1end_3:
    s_and_b32 s4, s2, 7
    s_lshl_b32 s80, s4, 3
    s_lshl_b32 s4, s4, 2
    s_bfe_u32 s8, s2, 0x20003
    s_add_u32 s4, s4, s8
    s_lshr_b32 s5, s2, 5
    s_bfe_u32 s8, s2, 0x30003
    s_add_u32 s80, s80, s8
    s_lshr_b32 s81, s2, 6
    s_and_b32 s6, s3, 3
    s_lshr_b32 s7, s3, 2
    v_lshlrev_b32 v119, 4, v1
    v_mov_b32 v124, 0
    v_mov_b32 v126, 0
    s_lshl_b32 s10, s7, 8
    s_add_u32 s10, s10, s71
    s_cmp_eq_u32 s7, 2
    s_cselect_b32 s10, s68, s10
    s_mul_i32 s11, s7, 21248
    s_add_u32 s11, s11, 98304
    s_mul_i32 s12, s4, 155648
    s_add_u32 s12, s12, 2560000
    s_cmp_eq_u32 s7, 3
    s_cbranch_scc1 L_kvload_47
    s_cmp_ge_u32 s10, 576
    s_cbranch_scc1 L_X_48
    s_lshl_b32 s8, s70, 16
    s_and_b32 s70, s70, 0xffff0000
    s_bitcmp0_b32 s10, 0
    s_cselect_b32 s70, s8, s70
    v_and_b32 v4, 15, v1
    v_lshrrev_b32 v5, 4, v1
    v_sub_u32 v6, 15, v4
    v_and_b32 v7, 1, v6
    v_and_b32 v6, 14, v6
    v_lshlrev_b32 v6, 1, v6
    v_lshl_add_u32 v6, v5, 4, v6
    v_mul_u32_u24 v7, 4160, v7
    s_and_b32 s8, s6, 1
    s_lshl_b32 s8, s8, 8
    s_sub_u32 s8, s11, s8
    v_add3_u32 v112, v6, v7, s8
    v_add_u32 v115, 1024, v112
    v_add_u32 v116, 2048, v112
    v_add_u32 v117, 3072, v112
    v_lshlrev_b32 v6, 5, v4
    v_lshl_add_u32 v7, v5, 4, v6
    s_add_u32 s8, s8, 16640
    v_add_u32 v113, s8, v7
    v_lshl_add_u32 v114, v5, 3, v6
    s_lshl_b32 s82, s7, 2
    s_add_u32 s82, s82, 163328
    v_mov_b32 v4, s82
    s_mov_b32 s31, 524288
L_lspin_52:
    ds_read_b32 v5, v4 offset:0
    s_waitcnt lgkmcnt(0)
    v_readfirstlane_b32 s8, v5
    s_cmp_ge_u32 s8, 2
    s_cbranch_scc1 L_lsdone_53
    s_sleep 1
    s_sub_u32 s31, s31, 1
    s_cbranch_scc0 L_lspin_52
L_lsdone_53:
    s_setprio 2
    s_cmp_ge_u32 s6, 2
    s_cbranch_scc1 L_ts1_49
    ds_read2_b32 v[8:9], v117 offset0:240 offset1:241
    ds_read2_b32 v[10:11], v117 offset0:242 offset1:243
    ds_read_b128 v[12:15], v113 offset:4064
    ds_read_b128 v[16:19], v113 offset:2528
    ds_read_b128 v[20:23], v113 offset:2016
    ds_read_b128 v[24:27], v113 offset:480
    ds_read2_b32 v[28:29], v117 offset0:112 offset1:113
    ds_read2_b32 v[30:31], v117 offset0:114 offset1:115
    ds_read_b128 v[32:35], v113 offset:3552
    ds_read_b128 v[36:39], v113 offset:1504
    ds_read2_b32 v[40:41], v116 offset0:240 offset1:241
    ds_read2_b32 v[42:43], v116 offset0:242 offset1:243
    ds_read_b128 v[44:47], v113 offset:3040
    ds_read_b128 v[48:51], v113 offset:992
    s_waitcnt lgkmcnt(11)
    v_mfma_f32_16x16x32_bf16 v[72:75], v[8:11], v[12:15], 0
    ds_read2_b32 v[52:53], v116 offset0:112 offset1:113
    ds_read2_b32 v[54:55], v116 offset0:114 offset1:115
    s_waitcnt lgkmcnt(12)
    v_mfma_f32_16x16x32_bf16 v[76:79], v[8:11], v[16:19], 0
    ds_read2_b32 v[56:57], v115 offset0:240 offset1:241
    ds_read2_b32 v[58:59], v115 offset0:242 offset1:243
    s_waitcnt lgkmcnt(13)
    v_mfma_f32_16x16x32_bf16 v[80:83], v[8:11], v[20:23], 0
    ds_read2_b32 v[60:61], v115 offset0:112 offset1:113
    ds_read2_b32 v[62:63], v115 offset0:114 offset1:115
    s_waitcnt lgkmcnt(14)
    v_mfma_f32_16x16x32_bf16 v[84:87], v[8:11], v[24:27], 0
    s_waitcnt lgkmcnt(11)
    ds_read2_b32 v[64:65], v112 offset0:240 offset1:241
    ds_read2_b32 v[66:67], v112 offset0:242 offset1:243
    v_mfma_f32_16x16x32_bf16 v[72:75], v[28:31], v[32:35], v[72:75]
    ds_read2_b32 v[68:69], v112 offset0:112 offset1:113
    ds_read2_b32 v[70:71], v112 offset0:114 offset1:115
    v_mfma_f32_16x16x32_bf16 v[76:79], v[28:31], v[20:23], v[76:79]
    s_waitcnt lgkmcnt(11)
    ds_read2_b32 v[88:89], v117 offset0:224 offset1:225
    ds_read2_b32 v[90:91], v117 offset0:226 offset1:227
    v_mfma_f32_16x16x32_bf16 v[80:83], v[28:31], v[36:39], v[80:83]
    ds_read_b128 v[92:95], v113 offset:4000
    v_mfma_f32_16x16x32_bf16 v[72:75], v[40:43], v[44:47], v[72:75]
    ds_read_b128 v[96:99], v113 offset:2464
    v_mfma_f32_16x16x32_bf16 v[76:79], v[40:43], v[36:39], v[76:79]
    s_waitcnt lgkmcnt(11)
    ds_read_b128 v[100:103], v113 offset:1952
    v_mfma_f32_16x16x32_bf16 v[80:83], v[40:43], v[48:51], v[80:83]
    ds_read_b128 v[104:107], v113 offset:416
    v_mfma_f32_16x16x32_bf16 v[72:75], v[52:55], v[16:19], v[72:75]
    ds_read2_b32 v[108:109], v117 offset0:96 offset1:97
    ds_read2_b32 v[110:111], v117 offset0:98 offset1:99
    v_mfma_f32_16x16x32_bf16 v[76:79], v[52:55], v[48:51], v[76:79]
    s_waitcnt lgkmcnt(11)
    ds_read_b128 v[12:15], v113 offset:3488
    v_mfma_f32_16x16x32_bf16 v[80:83], v[52:55], v[24:27], v[80:83]
    ds_read_b128 v[8:11], v113 offset:1440
    v_mfma_f32_16x16x32_bf16 v[72:75], v[56:59], v[20:23], v[72:75]
    ds_read2_b32 v[32:33], v116 offset0:224 offset1:225
    ds_read2_b32 v[34:35], v116 offset0:226 offset1:227
    v_mfma_f32_16x16x32_bf16 v[76:79], v[56:59], v[24:27], v[76:79]
    s_waitcnt lgkmcnt(11)
    ds_read_b128 v[28:31], v113 offset:2976
    v_mfma_f32_16x16x32_bf16 v[72:75], v[60:63], v[36:39], v[72:75]
    ds_read_b128 v[44:47], v113 offset:928
    v_mfma_f32_16x16x32_bf16 v[72:75], v[64:67], v[48:51], v[72:75]
    ds_read2_b32 v[40:41], v116 offset0:96 offset1:97
    ds_read2_b32 v[42:43], v116 offset0:98 offset1:99
    v_mfma_f32_16x16x32_bf16 v[72:75], v[68:71], v[24:27], v[72:75]
    s_waitcnt lgkmcnt(11)
    ds_read2_b32 v[16:17], v115 offset0:224 offset1:225
    ds_read2_b32 v[18:19], v115 offset0:226 offset1:227
    v_mfma_f32_16x16x32_bf16 v[72:75], v[88:91], v[92:95], v[72:75]
    ds_read2_b32 v[52:53], v115 offset0:96 offset1:97
    ds_read2_b32 v[54:55], v115 offset0:98 offset1:99
    v_mfma_f32_16x16x32_bf16 v[76:79], v[88:91], v[96:99], v[76:79]
    s_waitcnt lgkmcnt(11)
    ds_read2_b32 v[20:21], v112 offset0:224 offset1:225
    ds_read2_b32 v[22:23], v112 offset0:226 offset1:227
    v_mfma_f32_16x16x32_bf16 v[80:83], v[88:91], v[100:103], v[80:83]
    ds_read2_b32 v[56:57], v112 offset0:96 offset1:97
    ds_read2_b32 v[58:59], v112 offset0:98 offset1:99
    v_mfma_f32_16x16x32_bf16 v[84:87], v[88:91], v[104:107], v[84:87]
    s_waitcnt lgkmcnt(11)
    ds_read2_b32 v[60:61], v117 offset0:208 offset1:209
    ds_read2_b32 v[62:63], v117 offset0:210 offset1:211
    v_mfma_f32_16x16x32_bf16 v[72:75], v[108:111], v[12:15], v[72:75]
    ds_read_b128 v[36:39], v113 offset:3936
    v_mfma_f32_16x16x32_bf16 v[76:79], v[108:111], v[100:103], v[76:79]
    ds_read_b128 v[64:67], v113 offset:2400
    v_mfma_f32_16x16x32_bf16 v[80:83], v[108:111], v[8:11], v[80:83]
    s_waitcnt lgkmcnt(11)
    ds_read_b128 v[48:51], v113 offset:1888
    v_mfma_f32_16x16x32_bf16 v[72:75], v[32:35], v[28:31], v[72:75]
    ds_read_b128 v[68:71], v113 offset:352
    v_mfma_f32_16x16x32_bf16 v[76:79], v[32:35], v[8:11], v[76:79]
    ds_read2_b32 v[24:25], v117 offset0:80 offset1:81
    ds_read2_b32 v[26:27], v117 offset0:82 offset1:83
    v_mfma_f32_16x16x32_bf16 v[80:83], v[32:35], v[44:47], v[80:83]
    s_waitcnt lgkmcnt(11)
    ds_read_b128 v[92:95], v113 offset:3424
    v_mfma_f32_16x16x32_bf16 v[72:75], v[40:43], v[96:99], v[72:75]
    ds_read_b128 v[88:91], v113 offset:1376
    v_mfma_f32_16x16x32_bf16 v[76:79], v[40:43], v[44:47], v[76:79]
    ds_read2_b32 v[12:13], v116 offset0:208 offset1:209
    ds_read2_b32 v[14:15], v116 offset0:210 offset1:211
    v_mfma_f32_16x16x32_bf16 v[80:83], v[40:43], v[104:107], v[80:83]
    s_waitcnt lgkmcnt(11)
    ds_read_b128 v[108:111], v113 offset:2912
    v_mfma_f32_16x16x32_bf16 v[72:75], v[16:19], v[100:103], v[72:75]
    ds_read_b128 v[28:31], v113 offset:864
    v_mfma_f32_16x16x32_bf16 v[76:79], v[16:19], v[104:107], v[76:79]
    ds_read2_b32 v[32:33], v116 offset0:80 offset1:81
    ds_read2_b32 v[34:35], v116 offset0:82 offset1:83
    v_mfma_f32_16x16x32_bf16 v[72:75], v[52:55], v[8:11], v[72:75]
    s_waitcnt lgkmcnt(11)
    ds_read2_b32 v[96:97], v115 offset0:208 offset1:209
    ds_read2_b32 v[98:99], v115 offset0:210 offset1:211
    v_mfma_f32_16x16x32_bf16 v[72:75], v[20:23], v[44:47], v[72:75]
    ds_read2_b32 v[40:41], v115 offset0:80 offset1:81
    ds_read2_b32 v[42:43], v115 offset0:82 offset1:83
    v_mfma_f32_16x16x32_bf16 v[72:75], v[56:59], v[104:107], v[72:75]
    s_waitcnt lgkmcnt(11)
    ds_read2_b32 v[100:101], v112 offset0:208 offset1:209
    ds_read2_b32 v[102:103], v112 offset0:210 offset1:211
    v_mfma_f32_16x16x32_bf16 v[72:75], v[60:63], v[36:39], v[72:75]
    ds_read2_b32 v[16:17], v112 offset0:80 offset1:81
    ds_read2_b32 v[18:19], v112 offset0:82 offset1:83
    v_mfma_f32_16x16x32_bf16 v[76:79], v[60:63], v[64:67], v[76:79]
    s_waitcnt lgkmcnt(11)
    ds_read2_b32 v[52:53], v117 offset0:192 offset1:193
    ds_read2_b32 v[54:55], v117 offset0:194 offset1:195
    v_mfma_f32_16x16x32_bf16 v[80:83], v[60:63], v[48:51], v[80:83]
    ds_read_b128 v[8:11], v113 offset:3872
    v_mfma_f32_16x16x32_bf16 v[84:87], v[60:63], v[68:71], v[84:87]
    ds_read_b128 v[20:23], v113 offset:2336
    v_mfma_f32_16x16x32_bf16 v[72:75], v[24:27], v[92:95], v[72:75]
    s_waitcnt lgkmcnt(11)
    ds_read_b128 v[44:47], v113 offset:1824
    v_mfma_f32_16x16x32_bf16 v[76:79], v[24:27], v[48:51], v[76:79]
    ds_read_b128 v[56:59], v113 offset:288
    v_mfma_f32_16x16x32_bf16 v[80:83], v[24:27], v[88:91], v[80:83]
    ds_read2_b32 v[104:105], v117 offset0:64 offset1:65
    ds_read2_b32 v[106:107], v117 offset0:66 offset1:67
    v_mfma_f32_16x16x32_bf16 v[72:75], v[12:15], v[108:111], v[72:75]
    s_waitcnt lgkmcnt(11)
    ds_read_b128 v[36:39], v113 offset:3360
    v_mfma_f32_16x16x32_bf16 v[76:79], v[12:15], v[88:91], v[76:79]
    ds_read_b128 v[60:63], v113 offset:1312
    v_mfma_f32_16x16x32_bf16 v[80:83], v[12:15], v[28:31], v[80:83]
    ds_read2_b32 v[92:93], v116 offset0:192 offset1:193
    ds_read2_b32 v[94:95], v116 offset0:194 offset1:195
    v_mfma_f32_16x16x32_bf16 v[72:75], v[32:35], v[64:67], v[72:75]
    s_waitcnt lgkmcnt(11)
    ds_read_b128 v[24:27], v113 offset:2848
    v_mfma_f32_16x16x32_bf16 v[76:79], v[32:35], v[28:31], v[76:79]
    ds_read_b128 v[108:111], v113 offset:800
    v_mfma_f32_16x16x32_bf16 v[80:83], v[32:35], v[68:71], v[80:83]
    ds_read2_b32 v[12:13], v116 offset0:64 offset1:65
    ds_read2_b32 v[14:15], v116 offset0:66 offset1:67
    v_mfma_f32_16x16x32_bf16 v[72:75], v[96:99], v[48:51], v[72:75]
    s_waitcnt lgkmcnt(11)
    ds_read2_b32 v[64:65], v115 offset0:192 offset1:193
    ds_read2_b32 v[66:67], v115 offset0:194 offset1:195
    v_mfma_f32_16x16x32_bf16 v[76:79], v[96:99], v[68:71], v[76:79]
    ds_read2_b32 v[32:33], v115 offset0:64 offset1:65
    ds_read2_b32 v[34:35], v115 offset0:66 offset1:67
    v_mfma_f32_16x16x32_bf16 v[72:75], v[40:43], v[88:91], v[72:75]
    s_waitcnt lgkmcnt(11)
    ds_read2_b32 v[48:49], v112 offset0:192 offset1:193
    ds_read2_b32 v[50:51], v112 offset0:194 offset1:195
    v_mfma_f32_16x16x32_bf16 v[72:75], v[100:103], v[28:31], v[72:75]
    ds_read2_b32 v[96:97], v112 offset0:64 offset1:65
    ds_read2_b32 v[98:99], v112 offset0:66 offset1:67
    v_mfma_f32_16x16x32_bf16 v[72:75], v[16:19], v[68:71], v[72:75]
    v_mfma_f32_16x16x32_bf16 v[72:75], v[52:55], v[8:11], v[72:75]
    v_mfma_f32_16x16x32_bf16 v[76:79], v[52:55], v[20:23], v[76:79]
    v_mfma_f32_16x16x32_bf16 v[80:83], v[52:55], v[44:47], v[80:83]
    v_mfma_f32_16x16x32_bf16 v[84:87], v[52:55], v[56:59], v[84:87]
    v_mfma_f32_16x16x32_bf16 v[72:75], v[104:107], v[36:39], v[72:75]
    v_mfma_f32_16x16x32_bf16 v[76:79], v[104:107], v[44:47], v[76:79]
    s_waitcnt lgkmcnt(14)
    v_mfma_f32_16x16x32_bf16 v[80:83], v[104:107], v[60:63], v[80:83]
    s_waitcnt lgkmcnt(11)
    v_mfma_f32_16x16x32_bf16 v[72:75], v[92:95], v[24:27], v[72:75]
    v_mfma_f32_16x16x32_bf16 v[76:79], v[92:95], v[60:63], v[76:79]
    s_waitcnt lgkmcnt(10)
    v_mfma_f32_16x16x32_bf16 v[80:83], v[92:95], v[108:111], v[80:83]
    s_waitcnt lgkmcnt(8)
    v_mfma_f32_16x16x32_bf16 v[72:75], v[12:15], v[20:23], v[72:75]
    v_mfma_f32_16x16x32_bf16 v[76:79], v[12:15], v[108:111], v[76:79]
    v_mfma_f32_16x16x32_bf16 v[80:83], v[12:15], v[56:59], v[80:83]
    s_waitcnt lgkmcnt(6)
    v_mfma_f32_16x16x32_bf16 v[72:75], v[64:67], v[44:47], v[72:75]
    v_mfma_f32_16x16x32_bf16 v[76:79], v[64:67], v[56:59], v[76:79]
    s_waitcnt lgkmcnt(4)
    v_mfma_f32_16x16x32_bf16 v[72:75], v[32:35], v[60:63], v[72:75]
    s_waitcnt lgkmcnt(2)
    v_mfma_f32_16x16x32_bf16 v[72:75], v[48:51], v[108:111], v[72:75]
    s_waitcnt lgkmcnt(0)
    v_mfma_f32_16x16x32_bf16 v[72:75], v[96:99], v[56:59], v[72:75]
    s_cmp_eq_u32 s6, 0
    s_cselect_b32 s14, 7, 3
    s_cselect_b32 s15, 4, 0
    s_branch L_cj_50
L_ts1_49:
    ds_read2_b32 v[8:9], v117 offset0:240 offset1:241
    ds_read2_b32 v[10:11], v117 offset0:242 offset1:243
    ds_read_b128 v[12:15], v113 offset:3552
    ds_read_b128 v[16:19], v113 offset:3040
    ds_read_b128 v[20:23], v113 offset:1504
    ds_read_b128 v[24:27], v113 offset:992
    ds_read2_b32 v[28:29], v117 offset0:112 offset1:113
    ds_read2_b32 v[30:31], v117 offset0:114 offset1:115
    ds_read_b128 v[32:35], v113 offset:2528
    ds_read_b128 v[36:39], v113 offset:480
    ds_read2_b32 v[40:41], v116 offset0:240 offset1:241
    ds_read2_b32 v[42:43], v116 offset0:242 offset1:243
    ds_read_b128 v[44:47], v113 offset:2016
    ds_read2_b32 v[48:49], v116 offset0:112 offset1:113
    ds_read2_b32 v[50:51], v116 offset0:114 offset1:115
    s_waitcnt lgkmcnt(12)
    v_mfma_f32_16x16x32_bf16 v[72:75], v[8:11], v[12:15], 0
    ds_read2_b32 v[52:53], v115 offset0:240 offset1:241
    ds_read2_b32 v[54:55], v115 offset0:242 offset1:243
    s_waitcnt lgkmcnt(13)
    v_mfma_f32_16x16x32_bf16 v[76:79], v[8:11], v[16:19], 0
    ds_read2_b32 v[56:57], v115 offset0:112 offset1:113
    ds_read2_b32 v[58:59], v115 offset0:114 offset1:115
    s_waitcnt lgkmcnt(14)
    v_mfma_f32_16x16x32_bf16 v[80:83], v[8:11], v[20:23], 0
    s_waitcnt lgkmcnt(11)
    ds_read2_b32 v[60:61], v112 offset0:240 offset1:241
    ds_read2_b32 v[62:63], v112 offset0:242 offset1:243
    v_mfma_f32_16x16x32_bf16 v[84:87], v[8:11], v[24:27], 0
    ds_read2_b32 v[64:65], v117 offset0:224 offset1:225
    ds_read2_b32 v[66:67], v117 offset0:226 offset1:227
    v_mfma_f32_16x16x32_bf16 v[72:75], v[28:31], v[16:19], v[72:75]
    s_waitcnt lgkmcnt(11)
    ds_read_b128 v[68:71], v113 offset:3488
    v_mfma_f32_16x16x32_bf16 v[76:79], v[28:31], v[32:35], v[76:79]
    ds_read_b128 v[88:91], v113 offset:2976
    v_mfma_f32_16x16x32_bf16 v[80:83], v[28:31], v[24:27], v[80:83]
    ds_read_b128 v[92:95], v113 offset:1440
    v_mfma_f32_16x16x32_bf16 v[84:87], v[28:31], v[36:39], v[84:87]
    ds_read_b128 v[96:99], v113 offset:928
    v_mfma_f32_16x16x32_bf16 v[72:75], v[40:43], v[32:35], v[72:75]
    s_waitcnt lgkmcnt(11)
    ds_read2_b32 v[100:101], v117 offset0:96 offset1:97
    ds_read2_b32 v[102:103], v117 offset0:98 offset1:99
    v_mfma_f32_16x16x32_bf16 v[76:79], v[40:43], v[44:47], v[76:79]
    ds_read_b128 v[104:107], v113 offset:2464
    v_mfma_f32_16x16x32_bf16 v[80:83], v[40:43], v[36:39], v[80:83]
    ds_read_b128 v[108:111], v113 offset:416
    v_mfma_f32_16x16x32_bf16 v[72:75], v[48:51], v[44:47], v[72:75]
    s_waitcnt lgkmcnt(11)
    ds_read2_b32 v[12:13], v116 offset0:224 offset1:225
    ds_read2_b32 v[14:15], v116 offset0:226 offset1:227
    v_mfma_f32_16x16x32_bf16 v[76:79], v[48:51], v[20:23], v[76:79]
    ds_read_b128 v[8:11], v113 offset:1952
    v_mfma_f32_16x16x32_bf16 v[72:75], v[52:55], v[20:23], v[72:75]
    s_waitcnt lgkmcnt(11)
    ds_read2_b32 v[16:17], v116 offset0:96 offset1:97
    ds_read2_b32 v[18:19], v116 offset0:98 offset1:99
    v_mfma_f32_16x16x32_bf16 v[76:79], v[52:55], v[24:27], v[76:79]
    ds_read2_b32 v[28:29], v115 offset0:224 offset1:225
    ds_read2_b32 v[30:31], v115 offset0:226 offset1:227
    v_mfma_f32_16x16x32_bf16 v[72:75], v[56:59], v[24:27], v[72:75]
    s_waitcnt lgkmcnt(11)
    ds_read2_b32 v[32:33], v115 offset0:96 offset1:97
    ds_read2_b32 v[34:35], v115 offset0:98 offset1:99
    v_mfma_f32_16x16x32_bf16 v[76:79], v[56:59], v[36:39], v[76:79]
    ds_read2_b32 v[40:41], v112 offset0:224 offset1:225
    ds_read2_b32 v[42:43], v112 offset0:226 offset1:227
    v_mfma_f32_16x16x32_bf16 v[72:75], v[60:63], v[36:39], v[72:75]
    s_waitcnt lgkmcnt(11)
    ds_read2_b32 v[44:45], v117 offset0:208 offset1:209
    ds_read2_b32 v[46:47], v117 offset0:210 offset1:211
    v_mfma_f32_16x16x32_bf16 v[72:75], v[64:67], v[68:71], v[72:75]
    ds_read_b128 v[48:51], v113 offset:3424
    v_mfma_f32_16x16x32_bf16 v[76:79], v[64:67], v[88:91], v[76:79]
    ds_read_b128 v[20:23], v113 offset:2912
    v_mfma_f32_16x16x32_bf16 v[80:83], v[64:67], v[92:95], v[80:83]
    s_waitcnt lgkmcnt(11)
    ds_read_b128 v[52:55], v113 offset:1376
    v_mfma_f32_16x16x32_bf16 v[84:87], v[64:67], v[96:99], v[84:87]
    ds_read_b128 v[24:27], v113 offset:864
    v_mfma_f32_16x16x32_bf16 v[72:75], v[100:103], v[88:91], v[72:75]
    ds_read2_b32 v[56:57], v117 offset0:80 offset1:81
    ds_read2_b32 v[58:59], v117 offset0:82 offset1:83
    v_mfma_f32_16x16x32_bf16 v[76:79], v[100:103], v[104:107], v[76:79]
    s_waitcnt lgkmcnt(11)
    ds_read_b128 v[60:63], v113 offset:2400
    v_mfma_f32_16x16x32_bf16 v[80:83], v[100:103], v[96:99], v[80:83]
    ds_read_b128 v[36:39], v113 offset:352
    v_mfma_f32_16x16x32_bf16 v[84:87], v[100:103], v[108:111], v[84:87]
    ds_read2_b32 v[68:69], v116 offset0:208 offset1:209
    ds_read2_b32 v[70:71], v116 offset0:210 offset1:211
    v_mfma_f32_16x16x32_bf16 v[72:75], v[12:15], v[104:107], v[72:75]
    s_waitcnt lgkmcnt(11)
    ds_read_b128 v[64:67], v113 offset:1888
    v_mfma_f32_16x16x32_bf16 v[76:79], v[12:15], v[8:11], v[76:79]
    ds_read2_b32 v[88:89], v116 offset0:80 offset1:81
    ds_read2_b32 v[90:91], v116 offset0:82 offset1:83
    v_mfma_f32_16x16x32_bf16 v[80:83], v[12:15], v[108:111], v[80:83]
    s_waitcnt lgkmcnt(11)
    ds_read2_b32 v[100:101], v115 offset0:208 offset1:209
    ds_read2_b32 v[102:103], v115 offset0:210 offset1:211
    v_mfma_f32_16x16x32_bf16 v[72:75], v[16:19], v[8:11], v[72:75]
    ds_read2_b32 v[104:105], v115 offset0:80 offset1:81
    ds_read2_b32 v[106:107], v115 offset0:82 offset1:83
    v_mfma_f32_16x16x32_bf16 v[76:79], v[16:19], v[92:95], v[76:79]
    s_waitcnt lgkmcnt(11)
    ds_read2_b32 v[12:13], v112 offset0:208 offset1:209
    ds_read2_b32 v[14:15], v112 offset0:210 offset1:211
    v_mfma_f32_16x16x32_bf16 v[72:75], v[28:31], v[92:95], v[72:75]
    ds_read2_b32 v[8:9], v117 offset0:192 offset1:193
    ds_read2_b32 v[10:11], v117 offset0:194 offset1:195
    v_mfma_f32_16x16x32_bf16 v[76:79], v[28:31], v[96:99], v[76:79]
    s_waitcnt lgkmcnt(11)
    ds_read_b128 v[16:19], v113 offset:3360
    v_mfma_f32_16x16x32_bf16 v[72:75], v[32:35], v[96:99], v[72:75]
    ds_read_b128 v[92:95], v113 offset:2848
    v_mfma_f32_16x16x32_bf16 v[76:79], v[32:35], v[108:111], v[76:79]
    ds_read_b128 v[28:31], v113 offset:1312
    v_mfma_f32_16x16x32_bf16 v[72:75], v[40:43], v[108:111], v[72:75]
    ds_read_b128 v[96:99], v113 offset:800
    v_mfma_f32_16x16x32_bf16 v[72:75], v[44:47], v[48:51], v[72:75]
    s_waitcnt lgkmcnt(11)
    ds_read2_b32 v[32:33], v117 offset0:64 offset1:65
    ds_read2_b32 v[34:35], v117 offset0:66 offset1:67
    v_mfma_f32_16x16x32_bf16 v[76:79], v[44:47], v[20:23], v[76:79]
    ds_read_b128 v[40:43], v113 offset:2336
    v_mfma_f32_16x16x32_bf16 v[80:83], v[44:47], v[52:55], v[80:83]
    ds_read_b128 v[108:111], v113 offset:288
    v_mfma_f32_16x16x32_bf16 v[84:87], v[44:47], v[24:27], v[84:87]
    s_waitcnt lgkmcnt(11)
    ds_read2_b32 v[48:49], v116 offset0:192 offset1:193
    ds_read2_b32 v[50:51], v116 offset0:194 offset1:195
    v_mfma_f32_16x16x32_bf16 v[72:75], v[56:59], v[20:23], v[72:75]
    ds_read_b128 v[44:47], v113 offset:1824
    v_mfma_f32_16x16x32_bf16 v[76:79], v[56:59], v[60:63], v[76:79]
    s_waitcnt lgkmcnt(11)
    ds_read2_b32 v[20:21], v116 offset0:64 offset1:65
    ds_read2_b32 v[22:23], v116 offset0:66 offset1:67
    v_mfma_f32_16x16x32_bf16 v[80:83], v[56:59], v[24:27], v[80:83]
    v_mfma_f32_16x16x32_bf16 v[84:87], v[56:59], v[36:39], v[84:87]
    ds_read2_b32 v[56:57], v115 offset0:192 offset1:193
    ds_read2_b32 v[58:59], v115 offset0:194 offset1:195
    v_mfma_f32_16x16x32_bf16 v[72:75], v[68:71], v[60:63], v[72:75]
    s_waitcnt lgkmcnt(11)
    ds_read2_b32 v[60:61], v115 offset0:64 offset1:65
    ds_read2_b32 v[62:63], v115 offset0:66 offset1:67
    v_mfma_f32_16x16x32_bf16 v[76:79], v[68:71], v[64:67], v[76:79]
    v_mfma_f32_16x16x32_bf16 v[80:83], v[68:71], v[36:39], v[80:83]
    ds_read2_b32 v[68:69], v112 offset0:192 offset1:193
    ds_read2_b32 v[70:71], v112 offset0:194 offset1:195
    v_mfma_f32_16x16x32_bf16 v[72:75], v[88:91], v[64:67], v[72:75]
    v_mfma_f32_16x16x32_bf16 v[76:79], v[88:91], v[52:55], v[76:79]
    v_mfma_f32_16x16x32_bf16 v[72:75], v[100:103], v[52:55], v[72:75]
    v_mfma_f32_16x16x32_bf16 v[76:79], v[100:103], v[24:27], v[76:79]
    v_mfma_f32_16x16x32_bf16 v[72:75], v[104:107], v[24:27], v[72:75]
    v_mfma_f32_16x16x32_bf16 v[76:79], v[104:107], v[36:39], v[76:79]
    v_mfma_f32_16x16x32_bf16 v[72:75], v[12:15], v[36:39], v[72:75]
    v_mfma_f32_16x16x32_bf16 v[72:75], v[8:11], v[16:19], v[72:75]
    v_mfma_f32_16x16x32_bf16 v[76:79], v[8:11], v[92:95], v[76:79]
    v_mfma_f32_16x16x32_bf16 v[80:83], v[8:11], v[28:31], v[80:83]
    v_mfma_f32_16x16x32_bf16 v[84:87], v[8:11], v[96:99], v[84:87]
    s_waitcnt lgkmcnt(13)
    v_mfma_f32_16x16x32_bf16 v[72:75], v[32:35], v[92:95], v[72:75]
    s_waitcnt lgkmcnt(12)
    v_mfma_f32_16x16x32_bf16 v[76:79], v[32:35], v[40:43], v[76:79]
    v_mfma_f32_16x16x32_bf16 v[80:83], v[32:35], v[96:99], v[80:83]
    s_waitcnt lgkmcnt(11)
    v_mfma_f32_16x16x32_bf16 v[84:87], v[32:35], v[108:111], v[84:87]
    s_waitcnt lgkmcnt(9)
    v_mfma_f32_16x16x32_bf16 v[72:75], v[48:51], v[40:43], v[72:75]
    s_waitcnt lgkmcnt(8)
    v_mfma_f32_16x16x32_bf16 v[76:79], v[48:51], v[44:47], v[76:79]
    v_mfma_f32_16x16x32_bf16 v[80:83], v[48:51], v[108:111], v[80:83]
    s_waitcnt lgkmcnt(6)
    v_mfma_f32_16x16x32_bf16 v[72:75], v[20:23], v[44:47], v[72:75]
    v_mfma_f32_16x16x32_bf16 v[76:79], v[20:23], v[28:31], v[76:79]
    s_waitcnt lgkmcnt(4)
    v_mfma_f32_16x16x32_bf16 v[72:75], v[56:59], v[28:31], v[72:75]
    v_mfma_f32_16x16x32_bf16 v[76:79], v[56:59], v[96:99], v[76:79]
    s_waitcnt lgkmcnt(2)
    v_mfma_f32_16x16x32_bf16 v[72:75], v[60:63], v[96:99], v[72:75]
    v_mfma_f32_16x16x32_bf16 v[76:79], v[60:63], v[108:111], v[76:79]
    s_waitcnt lgkmcnt(0)
    v_mfma_f32_16x16x32_bf16 v[72:75], v[68:71], v[108:111], v[72:75]
    s_cmp_eq_u32 s6, 2
    s_cselect_b32 s14, 6, 2
    s_cselect_b32 s15, 5, 1
L_cj_50:
    s_lshl_b32 s14, s14, 9
    s_lshl_b32 s15, s15, 9
    s_lshl_b32 s8, s6, 11
    s_add_u32 s8, s8, s11
    v_add_u32 v4, s8, v119
    s_xor_b32 s8, s6, 1
    s_lshl_b32 s8, s8, 11
    s_add_u32 s8, s8, s11
    v_add_u32 v5, s8, v119
    s_add_u32 s8, s11, s14
    v_add_u32 v6, s8, v114
    s_add_u32 s8, s11, s15
    v_add_u32 v7, s8, v114
    ds_read_b64 v[8:9], v6 offset:17152
    ds_read_b64 v[10:11], v7 offset:17152
    s_bitcmp0_b32 s6, 0
    s_cbranch_scc1 L_sw_51
    v_swap_b32 v72, v80
    v_swap_b32 v73, v81
    v_swap_b32 v74, v82
    v_swap_b32 v75, v83
    v_swap_b32 v76, v84
    v_swap_b32 v77, v85
    v_swap_b32 v78, v86
    v_swap_b32 v79, v87
L_sw_51:
    s_nop 1
    ds_write_b128 v4, v[80:83] offset:8320
    ds_write_b128 v4, v[84:87] offset:9344
    v_mov_b32 v48, s82
    v_mov_b32 v49, 1
    s_mov_b64 exec, 1
    ds_add_u32 v48, v49 offset:32
    s_mov_b64 exec, -1
    s_waitcnt lgkmcnt(3)
    v_lshlrev_b32 v12, 16, v8
    v_and_b32 v13, 0xffff0000, v8
    v_fmac_f32 v72, s70, v12
    v_fmac_f32 v73, s70, v13
    v_lshlrev_b32 v12, 16, v9
    v_and_b32 v13, 0xffff0000, v9
    v_fmac_f32 v74, s70, v12
    v_fmac_f32 v75, s70, v13
    v_lshlrev_b32 v12, 16, v10
    v_and_b32 v13, 0xffff0000, v10
    v_fmac_f32 v76, s70, v12
    v_fmac_f32 v77, s70, v13
    v_lshlrev_b32 v12, 16, v11
    v_and_b32 v13, 0xffff0000, v11
    v_fmac_f32 v78, s70, v12
    v_fmac_f32 v79, s70, v13
    v_mov_b32 v48, s82
    s_mov_b32 s31, 524288
L_lspin_54:
    ds_read_b32 v49, v48 offset:32
    s_waitcnt lgkmcnt(0)
    v_readfirstlane_b32 s8, v49
    s_cmp_ge_u32 s8, 4
    s_cbranch_scc1 L_lsdone_55
    s_sleep 1
    s_sub_u32 s31, s31, 1
    s_cbranch_scc0 L_lspin_54
L_lsdone_55:
    ds_read_b128 v[40:43], v5 offset:8320
    ds_read_b128 v[44:47], v5 offset:9344
    s_lshl_b32 s8, s10, 12
    s_add_u32 s8, s8, 9900032
    s_add_u32 s14, s14, s8
    s_add_u32 s15, s15, s8
    s_waitcnt lgkmcnt(0)
    v_add_f32 v72, v72, v40
    v_add_f32 v73, v73, v41
    v_add_f32 v74, v74, v42
    v_add_f32 v75, v75, v43
    v_add_f32 v76, v76, v44
    v_add_f32 v77, v77, v45
    v_add_f32 v78, v78, v46
    v_add_f32 v79, v79, v47
    v_cvt_pk_bf16_f32 v122, v72, v73
    v_cvt_pk_bf16_f32 v123, v74, v75
    v_cvt_pk_bf16_f32 v124, v76, v77
    v_cvt_pk_bf16_f32 v125, v78, v79
    v_mov_b32 v126, v114
    s_cmp_lt_u32 s7, 2
    s_cbranch_scc1 L_X_48
    buffer_store_dwordx2 v[122:123], v126, s[52:55], s14 offen sc1
    buffer_store_dwordx2 v[124:125], v126, s[52:55], s15 offen sc1
    s_waitcnt vmcnt(0)
    v_mov_b32 v4, 163328
    v_mov_b32 v5, 1
    s_mov_b64 exec, 1
    ds_add_rtn_u32 v5, v4, v5 offset:140
    s_mov_b64 exec, -1
    s_waitcnt lgkmcnt(0)
    v_readfirstlane_b32 s8, v5
    s_cmp_lt_u32 s68, 576
    s_cselect_b32 s9, 11, 7
    s_cmp_lg_u32 s8, s9
    s_cbranch_scc1 L_X_48
    v_mov_b32 v4, 163328
    s_mov_b32 s31, 524288
L_lspin_56:
    ds_read_b32 v5, v4 offset:64
    s_waitcnt lgkmcnt(0)
    v_readfirstlane_b32 s8, v5
    s_cmp_ge_u32 s8, 8
    s_cbranch_scc1 L_lsdone_57
    s_sleep 1
    s_sub_u32 s31, s31, 1
    s_cbranch_scc0 L_lspin_56
L_lsdone_57:
    s_lshl_b32 s9, s2, 2
    s_add_u32 s9, s9, 2048
    v_mov_b32 v4, s30
    s_mov_b64 exec, 1
    buffer_store_dword v4, off, s[52:55], s9 sc1
    s_mov_b64 exec, -1
    s_branch L_X_48
L_kvload_47:
    v_and_b32 v6, 1, v1
    v_lshlrev_b32 v6, 5, v6
    v_add3_u32 v6, v6, 32, s4
    v_lshrrev_b32 v7, 1, v1
    s_lshl_b32 s8, s6, 2
    v_add_u32 v7, s8, v7
    s_lshl_b32 s8, s5, 1
    s_lshr_b32 s9, s6, 1
    s_add_u32 s8, s8, s9
    v_writelane_b32 v6, s4, 8
    v_writelane_b32 v7, s8, 8
    v_mul_u32_u24 v6, 43, v6
    v_lshrrev_b32 v6, 8, v6
    v_lshl_add_u32 v6, v6, 4, v7
    v_lshlrev_b32 v6, 7, v6
    v_add_u32 v6, 36864, v6
    v_mov_b32 v4, 163328
    s_mov_b32 s31, 524288
L_lspin_63:
    ds_read_b32 v5, v4 offset:144
    s_waitcnt lgkmcnt(0)
    v_readfirstlane_b32 s8, v5
    s_cmp_ge_u32 s8, 8
    s_cbranch_scc1 L_lsdone_64
    s_sleep 1
    s_sub_u32 s31, s31, 1
    s_cbranch_scc0 L_lspin_63
L_lsdone_64:
    s_lshl_b32 s74, s4, 3
    s_add_u32 s74, s74, s5
    s_lshl_b32 s75, s74, 2
    s_add_u32 s75, s75, s6
    s_mov_b32 s76, 0
    s_lshl_b32 s82, s6, 2
    s_add_u32 s82, s82, 163376
    v_mov_b32 v120, s82
    v_mov_b32 v121, 1
    s_mov_b32 s31, 524288
    s_mov_b64 exec, 0x1ff
    buffer_load_dword v8, v6, s[52:55], 0 offen sc1
    s_sleep 3
L_kp_58:
    s_mov_b64 exec, 0x1ff
    buffer_load_dword v9, v6, s[52:55], 0 offen sc1
    s_waitcnt vmcnt(1)
    v_cmp_ne_u32 vcc, s30, v8
    s_cmp_lt_u32 s76, 2
    s_cbranch_scc1 L_q_65
    s_sub_u32 s76, s76, 1
    s_cmp_lg_u32 s76, 1
    s_cbranch_scc1 L_q_65
    ds_write_b32 v120, v121
L_q_65:
    s_mov_b64 exec, -1
    s_sub_u32 s31, s31, 1
    s_cselect_b32 vcc_lo, 0, vcc_lo
    s_bitcmp1_b32 vcc_lo, 8
    s_cbranch_scc1 L_c_66
    s_cmp_lg_u32 s76, 0
    s_cbranch_scc1 L_nq_67
    s_mov_b32 s76, 3
    s_call_b64 s[78:79], L_qdma
L_nq_67:
    s_mov_b32 s77, 0
    s_and_b32 s8, vcc_lo, 0x0f
    s_cbranch_scc0 L_go_62
    s_mov_b32 s77, 1
    s_and_b32 s8, vcc_lo, 0xf0
    s_cbranch_scc0 L_go_62
L_c_66:
    s_sleep 3
    s_mov_b64 exec, 0x1ff
    buffer_load_dword v8, v6, s[52:55], 0 offen sc1
    s_waitcnt vmcnt(1)
    v_cmp_ne_u32 vcc, s30, v9
    s_cmp_lt_u32 s76, 2
    s_cbranch_scc1 L_q_68
    s_sub_u32 s76, s76, 1
    s_cmp_lg_u32 s76, 1
    s_cbranch_scc1 L_q_68
    ds_write_b32 v120, v121
L_q_68:
    s_mov_b64 exec, -1
    s_sub_u32 s31, s31, 1
    s_cselect_b32 vcc_lo, 0, vcc_lo
    s_bitcmp1_b32 vcc_lo, 8
    s_cbranch_scc1 L_c_69
    s_cmp_lg_u32 s76, 0
    s_cbranch_scc1 L_nq_70
    s_mov_b32 s76, 3
    s_call_b64 s[78:79], L_qdma
L_nq_70:
    s_mov_b32 s77, 0
    s_and_b32 s8, vcc_lo, 0x0f
    s_cbranch_scc0 L_go_62
    s_mov_b32 s77, 1
    s_and_b32 s8, vcc_lo, 0xf0
    s_cbranch_scc0 L_go_62
L_c_69:
    s_sleep 3
    s_branch L_kp_58
L_qdma:
    s_lshl_b32 s8, s6, 11
    s_add_u32 m0, s8, 77824
    s_lshl_b32 s9, s75, 11
    s_add_u32 s9, s9, 200704
    buffer_load_dwordx4 v119, s[52:55], s9 offen sc1 lds
    buffer_load_dwordx4 v119, s[52:55], s9 offen offset:1024 sc1 lds
    s_lshl_b32 s8, s6, 8
    s_add_u32 m0, s8, 86016
    s_lshl_b32 s9, s75, 8
    s_add_u32 s9, s9, 2297856
    s_mov_b64 exec, 0xffff
    buffer_load_dwordx4 v119, s[52:55], s9 offen sc1 lds
    s_mov_b64 exec, -1
    s_setpc_b64 s[78:79]
L_go_62:
    s_lshl_b32 s8, s6, 1
    s_add_u32 s8, s8, s77
    s_mul_i32 s8, s8, 19456
    s_add_u32 s8, s8, s12
    s_mul_i32 s82, s6, 19456
    s_add_u32 m0, s82, 0
    s_add_u32 s9, s8, 0
    buffer_load_dwordx4 v119, s[52:55], s9 offen offset:0 sc1 lds
    buffer_load_dwordx4 v119, s[52:55], s9 offen offset:1024 sc1 lds
    buffer_load_dwordx4 v119, s[52:55], s9 offen offset:2048 sc1 lds
    buffer_load_dwordx4 v119, s[52:55], s9 offen offset:3072 sc1 lds
    s_add_u32 m0, s82, 8192
    s_add_u32 s9, s8, 8192
    buffer_load_dwordx4 v119, s[52:55], s9 offen offset:0 sc1 lds
    buffer_load_dwordx4 v119, s[52:55], s9 offen offset:1024 sc1 lds
    buffer_load_dwordx4 v119, s[52:55], s9 offen offset:2048 sc1 lds
    buffer_load_dwordx4 v119, s[52:55], s9 offen offset:3072 sc1 lds
    s_add_u32 m0, s82, 12288
    s_add_u32 s9, s8, 12288
    buffer_load_dwordx4 v119, s[52:55], s9 offen offset:0 sc1 lds
    buffer_load_dwordx4 v119, s[52:55], s9 offen offset:1024 sc1 lds
    s_add_u32 m0, s82, 4096
    s_add_u32 s9, s8, 4096
    buffer_load_dwordx4 v119, s[52:55], s9 offen offset:0 sc1 lds
    buffer_load_dwordx4 v119, s[52:55], s9 offen offset:1024 sc1 lds
    buffer_load_dwordx4 v119, s[52:55], s9 offen offset:2048 sc1 lds
    buffer_load_dwordx4 v119, s[52:55], s9 offen offset:3072 sc1 lds
    s_add_u32 m0, s82, 14336
    s_add_u32 s9, s8, 14336
    buffer_load_dwordx4 v119, s[52:55], s9 offen offset:0 sc1 lds
    buffer_load_dwordx4 v119, s[52:55], s9 offen offset:1024 sc1 lds
    buffer_load_dwordx4 v119, s[52:55], s9 offen offset:2048 sc1 lds
    buffer_load_dwordx4 v119, s[52:55], s9 offen offset:3072 sc1 lds
    s_add_u32 m0, s82, 18432
    s_add_u32 s9, s8, 18432
    buffer_load_dwordx4 v119, s[52:55], s9 offen offset:0 sc1 lds
    s_lshl_b32 s78, s6, 3
    s_add_u32 s78, s78, 163520
    v_mov_b32 v4, s78
    v_mov_b32 v6, 1
    v_mov_b32 v7, s77
    v_mov_b32 v5, 2
    s_waitcnt vmcnt(9)
    ds_write_b32 v120, v121
    ds_write_b64 v4, v[6:7]
    s_waitcnt lgkmcnt(0)
    s_waitcnt vmcnt(0)
    ds_write_b32 v4, v5
L_X_48:
    s_mul_i32 s8, s7, 19456
    v_add_u32 v112, s8, v119
    v_and_b32 v4, 32, v1
    v_add_u32 v4, v4, v1
    v_lshl_add_u32 v113, v4, 2, s8
    v_add_u32 v113, 8192, v113
    v_bfe_u32 v4, v1, 2, 2
    v_and_b32 v5, 1, v1
    v_lshlrev_b32 v5, 4, v5
    v_and_b32 v6, 2, v1
    v_lshl_add_u32 v5, v6, 2, v5
    v_lshl_add_u32 v5, v4, 5, v5
    v_and_b32 v7, 32, v1
    v_lshl_add_u32 v5, v7, 3, v5
    v_lshl_add_u32 v4, v4, 3, v7
    v_add_u32 v4, 1152, v4
    v_and_b32 v6, 3, v1
    v_lshl_add_u32 v4, v6, 18, v4
    v_and_b32 v6, 16, v1
    v_cmp_eq_u32 vcc, 0, v6
    v_lshlrev_b32 v6, 4, v6
    v_mov_b32 v7, 512
    v_cndmask_b32 v5, v4, v5, vcc
    v_add_u32 v114, s8, v5
    v_sub_u32 v6, 128, v6
    v_cndmask_b32 v7, 64, v7, vcc
    v_add_u32 v115, v114, v6
    v_add_u32 v116, v114, v7
    v_add_u32 v117, v116, v6
    v_mov_b32 v118, 0xdddddddd
    s_mov_b32 s72, 729808896
    s_mov_b32 s73, 1568669696
    s_movk_i32 s64, 0x1f8
    s_mov_b64 s[62:63], 0
    s_lshl_b32 s8, s6, 11
    s_add_u32 s8, s8, 77824
    v_add_u32 v4, s8, v119
    v_and_b32 v5, 31, v1
    s_lshl_b32 s8, s6, 8
    s_add_u32 s8, s8, 86016
    v_lshl_add_u32 v5, v5, 2, s8
    v_cmp_gt_u32 vcc, 32, v1
    s_lshl_b32 s13, s5, 2
    s_add_u32 s13, s13, s6
    v_mov_b32 v97, 0
    v_mov_b32 v98, 0
    v_mov_b32 v101, 0
    v_mov_b32 v102, 0
    v_mov_b32 v40, 0
    v_mov_b32 v41, 0
    v_mov_b32 v42, 0
    v_mov_b32 v43, 0
    v_mov_b32 v44, 0
    v_mov_b32 v45, 0
    v_mov_b32 v46, 0
    v_mov_b32 v47, 0
    v_mov_b32 v48, 0
    v_mov_b32 v49, 0
    v_mov_b32 v50, 0
    v_mov_b32 v51, 0
    v_mov_b32 v52, 0
    v_mov_b32 v53, 0
    v_mov_b32 v54, 0
    v_mov_b32 v55, 0
    v_mov_b32 v105, 0
    v_mov_b32 v106, 0
    v_mov_b32 v109, 0
    v_mov_b32 v110, 0
    v_mov_b32 v56, 0
    v_mov_b32 v57, 0
    v_mov_b32 v58, 0
    v_mov_b32 v59, 0
    v_mov_b32 v60, 0
    v_mov_b32 v61, 0
    v_mov_b32 v62, 0
    v_mov_b32 v63, 0
    v_mov_b32 v64, 0
    v_mov_b32 v65, 0
    v_mov_b32 v66, 0
    v_mov_b32 v67, 0
    v_mov_b32 v68, 0
    v_mov_b32 v69, 0
    v_mov_b32 v70, 0
    v_mov_b32 v71, 0
    s_lshl_b32 s82, s6, 2
    s_add_u32 s82, s82, 163328
    s_lshl_b32 s83, s7, 3
    s_add_u32 s83, s83, 163328
    v_mov_b32 v120, s82
    s_mov_b32 s31, 524288
L_lspin_71:
    ds_read_b32 v121, v120 offset:48
    s_waitcnt lgkmcnt(0)
    v_readfirstlane_b32 s8, v121
    s_cmp_ge_u32 s8, 1
    s_cbranch_scc1 L_lsdone_72
    s_sleep 1
    s_sub_u32 s31, s31, 1
    s_cbranch_scc0 L_lspin_71
L_lsdone_72:
    ds_read_b128 v[88:91], v4
    ds_read_b128 v[92:95], v4 offset:1024
    ds_read2_b32 v[6:7], v5 offset0:0 offset1:32
    v_mov_b32 v120, 163328
    v_mov_b32 v121, 1
    s_mov_b64 exec, 1
    ds_add_u32 v120, v121 offset:136
    s_mov_b64 exec, -1
    s_waitcnt lgkmcnt(1)
    v_cndmask_b32 v96, 0, v6, vcc
    v_cndmask_b32 v99, 0, v6, vcc
    v_cndmask_b32 v100, v6, 0, vcc
    v_cndmask_b32 v103, v6, 0, vcc
    v_cndmask_b32 v104, 0, v7, vcc
    v_cndmask_b32 v107, 0, v7, vcc
    v_cndmask_b32 v108, v7, 0, vcc
    v_cndmask_b32 v111, v7, 0, vcc
    v_mov_b32 v120, s83
    s_mov_b32 s31, 524288
L_lspin_73:
    ds_read_b32 v121, v120 offset:192
    s_waitcnt lgkmcnt(0)
    v_readfirstlane_b32 s8, v121
    s_cmp_ge_u32 s8, 1
    s_cbranch_scc1 L_lsdone_74
    s_sleep 1
    s_sub_u32 s31, s31, 1
    s_cbranch_scc0 L_lspin_73
L_lsdone_74:
    ds_read2_b32 v[76:77], v113 offset0:0 offset1:32
    ds_read_b128 v[72:75], v112 offset:0
    ds_read_b64_tr_b16 v[80:81], v114 offset:9216
    ds_read_b64_tr_b16 v[82:83], v115 offset:9216
    s_waitcnt lgkmcnt(2)
    s_nop 0
    .p2align 3
    v_mfma_f32_32x32x8_bf16 v[8:23], v[76:77], v[96:97], 0
    v_mfma_f32_32x32x16_bf16 v[8:23], v[72:75], v[88:91], v[8:23]
    s_nop 11
    v_exp_f32 v8, v8
    v_exp_f32 v9, v9
    s_setprio 1
    ds_read_b64_tr_b16 v[84:85], v116 offset:9216
    ds_read_b64_tr_b16 v[86:87], v117 offset:9216
    v_exp_f32 v10, v10
    v_exp_f32 v11, v11
    v_exp_f32 v12, v12
    v_exp_f32 v13, v13
    v_mfma_f32_32x32x8_bf16 v[24:39], v[76:77], v[104:105], 0
    ds_read2_b32 v[78:79], v113 offset0:128 offset1:160
    v_exp_f32 v14, v14
    v_exp_f32 v15, v15
    v_exp_f32 v16, v16
    v_exp_f32 v17, v17
    v_mfma_f32_32x32x16_bf16 v[24:39], v[72:75], v[92:95], v[24:39]
    ds_read_b128 v[72:75], v112 offset:1024
    v_exp_f32 v18, v18
    v_exp_f32 v19, v19
    v_exp_f32 v20, v20
    v_exp_f32_e64 v21, v21
    s_waitcnt lgkmcnt(4)
    v_smfmac_f32_32x32x32_bf16 v[40:55], v[80:83], v[8:15], v118
    v_exp_f32 v22, v22
    v_exp_f32 v23, v23
    s_nop 2
    v_exp_f32_e64 v24, v24
    s_waitcnt lgkmcnt(0)
    v_smfmac_f32_32x32x32_bf16 v[40:55], v[84:87], v[16:23], v118
    v_exp_f32 v25, v25
    v_exp_f32 v26, v26
    v_exp_f32 v27, v27
    v_exp_f32 v28, v28
    v_exp_f32_e64 v29, v29
    v_mfma_f32_32x32x8_bf16 v[8:23], v[76:77], v[98:99], 0
    v_exp_f32 v30, v30
    v_exp_f32 v31, v31
    v_exp_f32 v32, v32
    v_exp_f32 v33, v33
    v_mfma_f32_32x32x16_bf16 v[8:23], v[72:75], v[88:91], v[8:23]
    v_exp_f32 v34, v34
    v_exp_f32 v35, v35
    v_exp_f32 v36, v36
    v_exp_f32 v37, v37
    v_smfmac_f32_32x32x32_bf16 v[56:71], v[80:83], v[24:31], v118
    ds_read_b64_tr_b16 v[80:81], v114 offset:10496
    ds_read_b64_tr_b16 v[82:83], v115 offset:10496
    v_exp_f32 v38, v38
    v_exp_f32 v39, v39
    s_nop 2
    v_exp_f32 v8, v8
    v_exp_f32_e64 v9, v9
    v_smfmac_f32_32x32x32_bf16 v[56:71], v[84:87], v[32:39], v118
    ds_read_b64_tr_b16 v[84:85], v116 offset:10496
    ds_read_b64_tr_b16 v[86:87], v117 offset:10496
    v_exp_f32 v10, v10
    v_exp_f32 v11, v11
    v_exp_f32 v12, v12
    v_exp_f32 v13, v13
    v_mfma_f32_32x32x8_bf16 v[24:39], v[76:77], v[106:107], 0
    v_exp_f32 v14, v14
    v_exp_f32 v15, v15
    v_exp_f32 v16, v16
    v_exp_f32 v17, v17
    v_mfma_f32_32x32x16_bf16 v[24:39], v[72:75], v[92:95], v[24:39]
    ds_read_b128 v[72:75], v112 offset:2048
    v_exp_f32 v18, v18
    v_exp_f32 v19, v19
    v_exp_f32 v20, v20
    v_exp_f32_e64 v21, v21
    s_waitcnt lgkmcnt(3)
    v_smfmac_f32_32x32x32_bf16 v[40:55], v[80:83], v[8:15], v118
    v_exp_f32 v22, v22
    v_exp_f32 v23, v23
    s_nop 2
    v_exp_f32 v24, v24
    s_waitcnt lgkmcnt(0)
    s_cmp_ge_u32 s3, 8
    s_cbranch_scc1 L_nw_75
    buffer_store_dwordx2 v[122:123], v126, s[52:55], s14 offen sc1
    buffer_store_dwordx2 v[124:125], v126, s[52:55], s15 offen sc1
    s_cmp_ge_u32 s3, 3
    s_cbranch_scc1 L_nw_75
    s_lshl_b32 s79, s3, 8
    s_add_u32 s79, s79, s2
    s_mov_b32 s56, s34
    s_mov_b32 s57, s35
    s_mov_b32 s58, 663552
    s_mov_b32 s59, 0x20000
    s_cmp_ge_u32 s79, 648
    s_cbranch_scc1 L_nowt_76
    v_lshrrev_b32 v4, 4, v1
    v_lshrrev_b32 v5, 1, v4
    v_mul_u32_u24 v5, 20, v5
    v_and_b32 v6, 1, v4
    v_lshl_add_u32 v5, v6, 3, v5
    v_mad_u32_u24 v6, v4, 36, 8
    v_lshlrev_b32 v6, 1, v6
    s_mul_i32 s77, s79, 3641
    s_lshr_b32 s77, s77, 16
    s_mul_i32 s76, s77, 18
    s_sub_u32 s76, s79, s76
    s_mul_i32 s8, s76, 41472
    s_sub_u32 s75, s76, 16
    s_mul_i32 s75, s75, 331776
    s_movk_i32 s78, 4608
    s_cmp_ge_u32 s76, 16
    s_cselect_b32 s8, s75, s8
    s_cselect_b32 s78, 41472, s78
    s_cselect_b64 vcc, -1, 0
    v_cndmask_b32 v5, v5, v6, vcc
    v_mul_u32_u24 v5, 1152, v5
    v_and_b32 v6, 15, v1
    v_lshl_add_u32 v5, v6, 1, v5
    s_lshl_b32 s77, s77, 5
    s_add_u32 s8, s8, s77
    s_add_u32 s78, s78, s8
    buffer_load_ushort v120, v5, s[56:59], s8 offen offset:0
    buffer_load_ushort v121, v5, s[56:59], s8 offen offset:1152
    buffer_load_ushort v122, v5, s[56:59], s8 offen offset:2304
    buffer_load_ushort v123, v5, s[56:59], s8 offen offset:3456
    buffer_load_ushort v124, v5, s[56:59], s78 offen offset:0
    buffer_load_ushort v125, v5, s[56:59], s78 offen offset:1152
    buffer_load_ushort v126, v5, s[56:59], s78 offen offset:2304
    buffer_load_ushort v127, v5, s[56:59], s78 offen offset:3456
L_nowt_76:
L_nw_75:
    .p2align 3
    v_smfmac_f32_32x32x32_bf16 v[40:55], v[84:87], v[16:23], v118
    v_exp_f32 v25, v25
    v_exp_f32 v26, v26
    v_exp_f32 v27, v27
    v_exp_f32 v28, v28
    v_exp_f32_e64 v29, v29
    v_mfma_f32_32x32x8_bf16 v[8:23], v[76:77], v[100:101], 0
    v_exp_f32 v30, v30
    v_exp_f32 v31, v31
    v_exp_f32 v32, v32
    v_exp_f32 v33, v33
    v_mfma_f32_32x32x16_bf16 v[8:23], v[72:75], v[88:91], v[8:23]
    v_exp_f32 v34, v34
    v_exp_f32 v35, v35
    v_exp_f32 v36, v36
    v_exp_f32 v37, v37
    v_smfmac_f32_32x32x32_bf16 v[56:71], v[80:83], v[24:31], v118
    ds_read_b64_tr_b16 v[80:81], v114 offset:11776
    ds_read_b64_tr_b16 v[82:83], v115 offset:11776
    v_exp_f32 v38, v38
    v_exp_f32 v39, v39
    s_nop 2
    v_exp_f32 v8, v8
    v_exp_f32_e64 v9, v9
    v_smfmac_f32_32x32x32_bf16 v[56:71], v[84:87], v[32:39], v118
    ds_read_b64_tr_b16 v[84:85], v116 offset:11776
    ds_read_b64_tr_b16 v[86:87], v117 offset:11776
    v_exp_f32 v10, v10
    v_exp_f32 v11, v11
    v_exp_f32 v12, v12
    v_exp_f32 v13, v13
    v_mfma_f32_32x32x8_bf16 v[24:39], v[76:77], v[108:109], 0
    v_exp_f32 v14, v14
    v_exp_f32 v15, v15
    v_exp_f32 v16, v16
    v_exp_f32 v17, v17
    v_mfma_f32_32x32x16_bf16 v[24:39], v[72:75], v[92:95], v[24:39]
    ds_read_b128 v[72:75], v112 offset:3072
    v_exp_f32 v18, v18
    v_exp_f32 v19, v19
    v_exp_f32 v20, v20
    v_exp_f32_e64 v21, v21
    s_waitcnt lgkmcnt(3)
    v_smfmac_f32_32x32x32_bf16 v[40:55], v[80:83], v[8:15], v118
    v_mov_b32 v4, s83
    ds_read_b32 v5, v4 offset:192
    .p2align 3
    v_exp_f32 v22, v22
    v_exp_f32 v23, v23
    s_nop 2
    v_exp_f32 v24, v24
    s_waitcnt lgkmcnt(0)
    v_cmp_gt_u32 vcc, 2, v5
    s_cbranch_vccz L_cok_77
    v_mov_b32 v4, s83
    s_mov_b32 s31, 524288
L_lspin_78:
    ds_read_b32 v5, v4 offset:192
    s_waitcnt lgkmcnt(0)
    v_readfirstlane_b32 s8, v5
    s_cmp_ge_u32 s8, 2
    s_cbranch_scc1 L_lsdone_79
    s_sleep 1
    s_sub_u32 s31, s31, 1
    s_cbranch_scc0 L_lspin_78
L_lsdone_79:
L_cok_77:
    .p2align 3
    v_smfmac_f32_32x32x32_bf16 v[40:55], v[84:87], v[16:23], v118
    v_exp_f32 v25, v25
    v_exp_f32 v26, v26
    v_exp_f32 v27, v27
    v_exp_f32 v28, v28
    v_exp_f32_e64 v29, v29
    v_mfma_f32_32x32x8_bf16 v[8:23], v[76:77], v[102:103], 0
    v_exp_f32 v30, v30
    v_exp_f32 v31, v31
    v_exp_f32 v32, v32
    v_exp_f32 v33, v33
    v_mfma_f32_32x32x16_bf16 v[8:23], v[72:75], v[88:91], v[8:23]
    v_exp_f32 v34, v34
    v_exp_f32 v35, v35
    v_exp_f32 v36, v36
    v_exp_f32 v37, v37
    v_smfmac_f32_32x32x32_bf16 v[56:71], v[80:83], v[24:31], v118
    ds_read_b64_tr_b16 v[80:81], v114 offset:13056
    ds_read_b64_tr_b16 v[82:83], v115 offset:13056
    v_exp_f32 v38, v38
    v_exp_f32 v39, v39
    s_nop 2
    v_exp_f32 v8, v8
    v_exp_f32_e64 v9, v9
    v_smfmac_f32_32x32x32_bf16 v[56:71], v[84:87], v[32:39], v118
    ds_read_b64_tr_b16 v[84:85], v116 offset:13056
    ds_read_b64_tr_b16 v[86:87], v117 offset:13056
    v_exp_f32 v10, v10
    v_exp_f32 v11, v11
    v_exp_f32 v12, v12
    v_exp_f32 v13, v13
    v_mfma_f32_32x32x8_bf16 v[24:39], v[76:77], v[110:111], 0
    v_exp_f32 v14, v14
    v_exp_f32 v15, v15
    v_exp_f32 v16, v16
    v_exp_f32 v17, v17
    v_mfma_f32_32x32x16_bf16 v[24:39], v[72:75], v[92:95], v[24:39]
    ds_read_b128 v[72:75], v112 offset:4096
    v_exp_f32 v18, v18
    v_exp_f32 v19, v19
    v_exp_f32 v20, v20
    v_exp_f32_e64 v21, v21
    s_waitcnt lgkmcnt(3)
    v_smfmac_f32_32x32x32_bf16 v[40:55], v[80:83], v[8:15], v118
    v_exp_f32 v22, v22
    v_exp_f32 v23, v23
    s_nop 2
    v_exp_f32_e64 v24, v24
    s_waitcnt lgkmcnt(0)
    v_smfmac_f32_32x32x32_bf16 v[40:55], v[84:87], v[16:23], v118
    v_exp_f32 v25, v25
    v_exp_f32 v26, v26
    v_exp_f32 v27, v27
    v_exp_f32 v28, v28
    v_exp_f32_e64 v29, v29
    v_mfma_f32_32x32x8_bf16 v[8:23], v[78:79], v[96:97], 0
    v_exp_f32 v30, v30
    v_exp_f32 v31, v31
    v_exp_f32 v32, v32
    v_exp_f32 v33, v33
    v_mfma_f32_32x32x16_bf16 v[8:23], v[72:75], v[88:91], v[8:23]
    v_exp_f32 v34, v34
    v_exp_f32 v35, v35
    v_exp_f32 v36, v36
    v_exp_f32 v37, v37
    v_smfmac_f32_32x32x32_bf16 v[56:71], v[80:83], v[24:31], v118
    ds_read_b64_tr_b16 v[80:81], v114 offset:14336
    ds_read_b64_tr_b16 v[82:83], v115 offset:14336
    v_exp_f32 v38, v38
    v_exp_f32 v39, v39
    s_nop 2
    v_exp_f32 v8, v8
    v_exp_f32_e64 v9, v9
    v_smfmac_f32_32x32x32_bf16 v[56:71], v[84:87], v[32:39], v118
    ds_read_b64_tr_b16 v[84:85], v116 offset:14336
    ds_read_b64_tr_b16 v[86:87], v117 offset:14336
    v_exp_f32 v10, v10
    v_exp_f32 v11, v11
    v_exp_f32 v12, v12
    v_exp_f32 v13, v13
    v_mfma_f32_32x32x8_bf16 v[24:39], v[78:79], v[104:105], 0
    v_exp_f32 v14, v14
    v_exp_f32 v15, v15
    v_exp_f32 v16, v16
    v_exp_f32 v17, v17
    v_mfma_f32_32x32x16_bf16 v[24:39], v[72:75], v[92:95], v[24:39]
    ds_read_b128 v[72:75], v112 offset:5120
    v_exp_f32 v18, v18
    v_exp_f32 v19, v19
    v_exp_f32 v20, v20
    v_exp_f32_e64 v21, v21
    s_waitcnt lgkmcnt(3)
    v_smfmac_f32_32x32x32_bf16 v[40:55], v[80:83], v[8:15], v118
    v_exp_f32 v22, v22
    v_exp_f32 v23, v23
    s_nop 2
    v_exp_f32 v24, v24
    s_waitcnt lgkmcnt(0)
    s_cmp_ge_u32 s3, 8
    s_cbranch_scc1 L_ns_81
    s_cmp_ge_u32 s3, 3
    s_cbranch_scc1 L_nw_80
    s_waitcnt vmcnt(0)
    s_cmp_ge_u32 s79, 648
    s_cbranch_scc1 L_wtskip_82
    v_lshl_or_b32 v120, v121, 16, v120
    v_lshl_or_b32 v121, v123, 16, v122
    v_lshl_or_b32 v122, v125, 16, v124
    v_lshl_or_b32 v123, v127, 16, v126
    s_lshl_b32 s79, s79, 10
    s_add_u32 s79, s79, 12259328
    buffer_store_dwordx4 v[120:123], v119, s[52:55], s79 offen sc1
L_wtskip_82:
L_nw_80:
    s_lshr_b32 s78, s3, 1
    v_and_b32 v124, 1, v1
    v_lshlrev_b32 v124, 5, v124
    v_add3_u32 v124, v124, 32, s4
    v_lshrrev_b32 v125, 1, v1
    s_lshl_b32 s8, s78, 2
    v_add_u32 v125, s8, v125
    s_lshl_b32 s8, s5, 1
    s_lshr_b32 s9, s6, 1
    s_add_u32 s8, s8, s9
    v_writelane_b32 v124, s4, 8
    v_writelane_b32 v125, s8, 8
    v_mul_u32_u24 v124, 43, v124
    v_lshrrev_b32 v124, 8, v124
    v_lshl_add_u32 v124, v124, 4, v125
    v_lshlrev_b32 v124, 7, v124
    v_add_u32 v124, 36864, v124
    s_mov_b64 exec, 0xff
    buffer_load_dword v125, v124, s[52:55], 0 offen offset:0 sc1
    s_mov_b64 exec, -1
L_ns_81:
    .p2align 3
    v_smfmac_f32_32x32x32_bf16 v[40:55], v[84:87], v[16:23], v118
    v_exp_f32 v25, v25
    v_exp_f32 v26, v26
    v_exp_f32 v27, v27
    v_exp_f32 v28, v28
    v_exp_f32_e64 v29, v29
    v_mfma_f32_32x32x8_bf16 v[8:23], v[78:79], v[98:99], 0
    v_exp_f32 v30, v30
    v_exp_f32 v31, v31
    v_exp_f32 v32, v32
    v_exp_f32 v33, v33
    v_mfma_f32_32x32x16_bf16 v[8:23], v[72:75], v[88:91], v[8:23]
    v_exp_f32 v34, v34
    v_exp_f32 v35, v35
    v_exp_f32 v36, v36
    v_exp_f32 v37, v37
    v_smfmac_f32_32x32x32_bf16 v[56:71], v[80:83], v[24:31], v118
    ds_read_b64_tr_b16 v[80:81], v114 offset:15616
    ds_read_b64_tr_b16 v[82:83], v115 offset:15616
    v_exp_f32 v38, v38
    v_exp_f32 v39, v39
    s_nop 2
    v_exp_f32 v8, v8
    v_exp_f32_e64 v9, v9
    v_smfmac_f32_32x32x32_bf16 v[56:71], v[84:87], v[32:39], v118
    ds_read_b64_tr_b16 v[84:85], v116 offset:15616
    ds_read_b64_tr_b16 v[86:87], v117 offset:15616
    v_exp_f32 v10, v10
    v_exp_f32 v11, v11
    v_exp_f32 v12, v12
    v_exp_f32 v13, v13
    v_mfma_f32_32x32x8_bf16 v[24:39], v[78:79], v[106:107], 0
    v_exp_f32 v14, v14
    v_exp_f32 v15, v15
    v_exp_f32 v16, v16
    v_exp_f32 v17, v17
    v_mfma_f32_32x32x16_bf16 v[24:39], v[72:75], v[92:95], v[24:39]
    ds_read_b128 v[72:75], v112 offset:6144
    v_exp_f32 v18, v18
    v_exp_f32 v19, v19
    v_exp_f32 v20, v20
    v_exp_f32_e64 v21, v21
    s_waitcnt lgkmcnt(3)
    v_smfmac_f32_32x32x32_bf16 v[40:55], v[80:83], v[8:15], v118
    v_exp_f32 v22, v22
    v_exp_f32 v23, v23
    s_nop 2
    v_exp_f32 v24, v24
    s_waitcnt lgkmcnt(0)
    s_cmp_ge_u32 s3, 8
    s_cbranch_scc1 L_kvs_83
    s_mov_b64 exec, 0xff
    s_mov_b32 s31, 524288
    s_branch L_pollchk_86
L_poll_85:
    buffer_load_dword v125, v124, s[52:55], 0 offen offset:0 sc1
L_pollchk_86:
    s_waitcnt vmcnt(0)
    v_cmp_ne_u32 vcc, s30, v125
    s_cbranch_vccz L_polld_87
    s_sleep 6
    s_sub_u32 s31, s31, 1
    s_cbranch_scc0 L_poll_85
L_polld_87:
    s_mov_b64 exec, -1
    v_mov_b32 v4, 163328
    v_mov_b32 v5, 1
    s_mov_b64 exec, 1
    ds_add_rtn_u32 v5, v4, v5 offset:140
    s_mov_b64 exec, -1
    s_waitcnt lgkmcnt(0)
    v_readfirstlane_b32 s8, v5
    s_cmp_lt_u32 s68, 576
    s_cselect_b32 s9, 11, 7
    s_cmp_lg_u32 s8, s9
    s_cbranch_scc1 L_nw_84
    v_mov_b32 v4, 163328
    s_mov_b32 s31, 524288
L_lspin_88:
    ds_read_b32 v5, v4 offset:64
    s_waitcnt lgkmcnt(0)
    v_readfirstlane_b32 s8, v5
    s_cmp_ge_u32 s8, 8
    s_cbranch_scc1 L_lsdone_89
    s_sleep 1
    s_sub_u32 s31, s31, 1
    s_cbranch_scc0 L_lspin_88
L_lsdone_89:
    s_lshl_b32 s9, s2, 2
    s_add_u32 s9, s9, 2048
    v_mov_b32 v4, s30
    s_mov_b64 exec, 1
    buffer_store_dword v4, off, s[52:55], s9 sc1
    s_mov_b64 exec, -1
L_nw_84:
    v_mov_b32 v4, 163328
    s_mov_b32 s31, 524288
L_lspin_90:
    ds_read_b32 v5, v4 offset:136
    s_waitcnt lgkmcnt(0)
    v_readfirstlane_b32 s8, v5
    s_cmp_ge_u32 s8, 16
    s_cbranch_scc1 L_lsdone_91
    s_sleep 1
    s_sub_u32 s31, s31, 1
    s_cbranch_scc0 L_lspin_90
L_lsdone_91:
    s_lshl_b32 s82, s78, 3
    s_add_u32 s82, s82, 163328
    v_mov_b32 v4, s82
    s_mov_b32 s31, 524288
L_lspin_92:
    ds_read_b32 v5, v4 offset:192
    s_waitcnt lgkmcnt(0)
    v_readfirstlane_b32 s8, v5
    s_cmp_ge_u32 s8, 1
    s_cbranch_scc1 L_lsdone_93
    s_sleep 1
    s_sub_u32 s31, s31, 1
    s_cbranch_scc0 L_lspin_92
L_lsdone_93:
    ds_read_b32 v5, v4 offset:196
    s_and_b32 s8, s3, 6
    s_waitcnt lgkmcnt(0)
    v_readfirstlane_b32 s9, v5
    s_xor_b32 s9, s9, 1
    s_and_b32 s9, s9, 1
    s_add_u32 s8, s8, s9
    s_mul_i32 s8, s8, 19456
    s_add_u32 s8, s8, s12
    s_and_b32 s9, s3, 1
    s_mul_i32 s9, s9, 9216
    s_add_u32 s8, s8, s9
    s_mul_i32 s82, s78, 19456
    s_add_u32 s82, s82, s9
    s_add_u32 m0, s82, 77824
    s_nop 0
    buffer_load_dwordx4 v119, s[52:55], s8 offen offset:0 sc1 lds
    buffer_load_dwordx4 v119, s[52:55], s8 offen offset:1024 sc1 lds
    buffer_load_dwordx4 v119, s[52:55], s8 offen offset:2048 sc1 lds
    buffer_load_dwordx4 v119, s[52:55], s8 offen offset:3072 sc1 lds
    s_add_u32 m0, m0, 4096
    s_add_u32 s8, s8, 4096
    buffer_load_dwordx4 v119, s[52:55], s8 offen offset:0 sc1 lds
    buffer_load_dwordx4 v119, s[52:55], s8 offen offset:1024 sc1 lds
    buffer_load_dwordx4 v119, s[52:55], s8 offen offset:2048 sc1 lds
    buffer_load_dwordx4 v119, s[52:55], s8 offen offset:3072 sc1 lds
    s_add_u32 m0, m0, 4096
    s_add_u32 s8, s8, 4096
    buffer_load_dwordx4 v119, s[52:55], s8 offen offset:0 sc1 lds
    buffer_load_dwordx4 v119, s[52:55], s8 offen offset:1024 sc1 lds
L_kvs_83:
    .p2align 3
    v_smfmac_f32_32x32x32_bf16 v[40:55], v[84:87], v[16:23], v118
    v_exp_f32 v25, v25
    v_exp_f32 v26, v26
    v_exp_f32 v27, v27
    v_exp_f32 v28, v28
    v_exp_f32_e64 v29, v29
    v_mfma_f32_32x32x8_bf16 v[8:23], v[78:79], v[100:101], 0
    v_exp_f32 v30, v30
    v_exp_f32 v31, v31
    v_exp_f32 v32, v32
    v_exp_f32 v33, v33
    v_mfma_f32_32x32x16_bf16 v[8:23], v[72:75], v[88:91], v[8:23]
    v_exp_f32 v34, v34
    v_exp_f32 v35, v35
    v_exp_f32 v36, v36
    v_exp_f32 v37, v37
    v_smfmac_f32_32x32x32_bf16 v[56:71], v[80:83], v[24:31], v118
    ds_read_b64_tr_b16 v[80:81], v114 offset:16896
    ds_read_b64_tr_b16 v[82:83], v115 offset:16896
    v_exp_f32 v38, v38
    v_exp_f32 v39, v39
    s_nop 2
    v_exp_f32 v8, v8
    v_exp_f32 v9, v9
    s_setprio 0
    v_smfmac_f32_32x32x32_bf16 v[56:71], v[84:87], v[32:39], v118
    ds_read_b64_tr_b16 v[84:85], v116 offset:16896
    ds_read_b64_tr_b16 v[86:87], v117 offset:16896
    v_exp_f32 v10, v10
    v_exp_f32 v11, v11
    v_exp_f32 v12, v12
    v_exp_f32 v13, v13
    v_mfma_f32_32x32x8_bf16 v[24:39], v[78:79], v[108:109], 0
    v_exp_f32 v14, v14
    v_exp_f32 v15, v15
    v_exp_f32 v16, v16
    v_exp_f32 v17, v17
    v_mfma_f32_32x32x16_bf16 v[24:39], v[72:75], v[92:95], v[24:39]
    ds_read_b128 v[72:75], v112 offset:7168
    v_exp_f32 v18, v18
    v_exp_f32 v19, v19
    v_exp_f32 v20, v20
    v_exp_f32_e64 v21, v21
    s_waitcnt lgkmcnt(3)
    v_smfmac_f32_32x32x32_bf16 v[40:55], v[80:83], v[8:15], v118
    v_exp_f32 v22, v22
    v_exp_f32 v23, v23
    s_nop 2
    v_exp_f32_e64 v24, v24
    s_waitcnt lgkmcnt(0)
    v_smfmac_f32_32x32x32_bf16 v[40:55], v[84:87], v[16:23], v118
    v_exp_f32 v25, v25
    v_exp_f32 v26, v26
    v_exp_f32 v27, v27
    v_exp_f32 v28, v28
    v_exp_f32_e64 v29, v29
    v_mfma_f32_32x32x8_bf16 v[8:23], v[78:79], v[102:103], 0
    v_exp_f32 v30, v30
    v_exp_f32 v31, v31
    v_exp_f32 v32, v32
    v_exp_f32 v33, v33
    v_mfma_f32_32x32x16_bf16 v[8:23], v[72:75], v[88:91], v[8:23]
    v_exp_f32 v34, v34
    v_exp_f32 v35, v35
    v_exp_f32 v36, v36
    v_exp_f32 v37, v37
    v_smfmac_f32_32x32x32_bf16 v[56:71], v[80:83], v[24:31], v118
    ds_read_b64_tr_b16 v[80:81], v114 offset:18176
    ds_read_b64_tr_b16 v[82:83], v115 offset:18176
    v_exp_f32 v38, v38
    v_exp_f32 v39, v39
    s_nop 2
    v_exp_f32 v8, v8
    v_exp_f32_e64 v9, v9
    v_smfmac_f32_32x32x32_bf16 v[56:71], v[84:87], v[32:39], v118
    ds_read_b64_tr_b16 v[84:85], v116 offset:18176
    ds_read_b64_tr_b16 v[86:87], v117 offset:18176
    v_exp_f32 v10, v10
    v_exp_f32 v11, v11
    v_exp_f32 v12, v12
    v_exp_f32 v13, v13
    v_mfma_f32_32x32x8_bf16 v[24:39], v[78:79], v[110:111], 0
    v_exp_f32 v14, v14
    v_exp_f32 v15, v15
    v_exp_f32 v16, v16
    v_exp_f32 v17, v17
    v_mfma_f32_32x32x16_bf16 v[24:39], v[72:75], v[92:95], v[24:39]
    s_nop 0
    v_exp_f32 v18, v18
    v_exp_f32 v19, v19
    v_exp_f32 v20, v20
    v_exp_f32 v21, v21
    s_waitcnt lgkmcnt(2)
    v_smfmac_f32_32x32x32_bf16 v[40:55], v[80:83], v[8:15], v118
    v_exp_f32 v22, v22
    v_exp_f32 v23, v23
    s_nop 2
    v_exp_f32 v24, v24
    s_waitcnt lgkmcnt(0)
    s_waitcnt vmcnt(0)
    s_setprio 2
    s_barrier
    .p2align 3
    v_add_u32 v112, 77824, v112
    v_add_u32 v113, 77824, v113
    ds_read2_b32 v[76:77], v113 offset0:0 offset1:32
    ds_read_b128 v[72:75], v112 offset:0
    v_add_u32 v114, 77824, v114
    v_add_u32 v115, 77824, v115
    v_add_u32 v116, 77824, v116
    v_add_u32 v117, 77824, v117
    v_smfmac_f32_32x32x32_bf16 v[40:55], v[84:87], v[16:23], v118
    v_exp_f32 v25, v25
    v_exp_f32 v26, v26
    v_exp_f32 v27, v27
    v_exp_f32 v28, v28
    v_exp_f32 v29, v29
    s_waitcnt lgkmcnt(0)
    v_mfma_f32_32x32x8_bf16 v[8:23], v[76:77], v[96:97], 0
    v_exp_f32 v30, v30
    v_exp_f32 v31, v31
    v_exp_f32 v32, v32
    v_exp_f32 v33, v33
    v_mfma_f32_32x32x16_bf16 v[8:23], v[72:75], v[88:91], v[8:23]
    v_exp_f32 v34, v34
    v_exp_f32 v35, v35
    v_exp_f32 v36, v36
    v_exp_f32 v37, v37
    v_smfmac_f32_32x32x32_bf16 v[56:71], v[80:83], v[24:31], v118
    ds_read_b64_tr_b16 v[80:81], v114 offset:9216
    ds_read_b64_tr_b16 v[82:83], v115 offset:9216
    v_exp_f32 v38, v38
    v_exp_f32 v39, v39
    s_nop 2
    v_exp_f32 v8, v8
    v_exp_f32_e64 v9, v9
    v_smfmac_f32_32x32x32_bf16 v[56:71], v[84:87], v[32:39], v118
    ds_read_b64_tr_b16 v[84:85], v116 offset:9216
    ds_read_b64_tr_b16 v[86:87], v117 offset:9216
    v_exp_f32 v10, v10
    v_exp_f32 v11, v11
    v_exp_f32 v12, v12
    v_exp_f32 v13, v13
    v_mfma_f32_32x32x8_bf16 v[24:39], v[76:77], v[104:105], 0
    ds_read2_b32 v[78:79], v113 offset0:128 offset1:160
    v_exp_f32 v14, v14
    v_exp_f32 v15, v15
    v_exp_f32 v16, v16
    v_exp_f32 v17, v17
    v_mfma_f32_32x32x16_bf16 v[24:39], v[72:75], v[92:95], v[24:39]
    ds_read_b128 v[72:75], v112 offset:1024
    v_exp_f32 v18, v18
    v_exp_f32 v19, v19
    v_exp_f32 v20, v20
    v_exp_f32_e64 v21, v21
    s_waitcnt lgkmcnt(4)
    v_smfmac_f32_32x32x32_bf16 v[40:55], v[80:83], v[8:15], v118
    v_exp_f32 v22, v22
    v_exp_f32 v23, v23
    s_nop 2
    v_exp_f32 v24, v24
    s_waitcnt lgkmcnt(0)
    s_cmp_lg_u32 s3, 0
    s_cbranch_scc1 L_nopa_94
    buffer_load_dwordx4 v[120:123], v119, s[52:55], 0 offen offset:2048 sc1
L_nopa_94:
    .p2align 3
    v_smfmac_f32_32x32x32_bf16 v[40:55], v[84:87], v[16:23], v118
    v_exp_f32 v25, v25
    v_exp_f32 v26, v26
    v_exp_f32 v27, v27
    v_exp_f32 v28, v28
    v_exp_f32_e64 v29, v29
    v_mfma_f32_32x32x8_bf16 v[8:23], v[76:77], v[98:99], 0
    v_exp_f32 v30, v30
    v_exp_f32 v31, v31
    v_exp_f32 v32, v32
    v_exp_f32 v33, v33
    v_mfma_f32_32x32x16_bf16 v[8:23], v[72:75], v[88:91], v[8:23]
    v_exp_f32 v34, v34
    v_exp_f32 v35, v35
    v_exp_f32 v36, v36
    v_exp_f32 v37, v37
    v_smfmac_f32_32x32x32_bf16 v[56:71], v[80:83], v[24:31], v118
    ds_read_b64_tr_b16 v[80:81], v114 offset:10496
    ds_read_b64_tr_b16 v[82:83], v115 offset:10496
    v_exp_f32 v38, v38
    v_exp_f32 v39, v39
    s_nop 2
    v_exp_f32 v8, v8
    v_exp_f32_e64 v9, v9
    v_smfmac_f32_32x32x32_bf16 v[56:71], v[84:87], v[32:39], v118
    ds_read_b64_tr_b16 v[84:85], v116 offset:10496
    ds_read_b64_tr_b16 v[86:87], v117 offset:10496
    v_exp_f32 v10, v10
    v_exp_f32 v11, v11
    v_exp_f32 v12, v12
    v_exp_f32 v13, v13
    v_mfma_f32_32x32x8_bf16 v[24:39], v[76:77], v[106:107], 0
    v_exp_f32 v14, v14
    v_exp_f32 v15, v15
    v_exp_f32 v16, v16
    v_exp_f32 v17, v17
    v_mfma_f32_32x32x16_bf16 v[24:39], v[72:75], v[92:95], v[24:39]
    ds_read_b128 v[72:75], v112 offset:2048
    v_exp_f32 v18, v18
    v_exp_f32 v19, v19
    v_exp_f32 v20, v20
    v_exp_f32_e64 v21, v21
    s_waitcnt lgkmcnt(3)
    v_smfmac_f32_32x32x32_bf16 v[40:55], v[80:83], v[8:15], v118
    v_exp_f32 v22, v22
    v_exp_f32 v23, v23
    s_nop 2
    v_exp_f32_e64 v24, v24
    s_waitcnt lgkmcnt(0)
    v_smfmac_f32_32x32x32_bf16 v[40:55], v[84:87], v[16:23], v118
    v_exp_f32 v25, v25
    v_exp_f32 v26, v26
    v_exp_f32 v27, v27
    v_exp_f32 v28, v28
    v_exp_f32_e64 v29, v29
    v_mfma_f32_32x32x8_bf16 v[8:23], v[76:77], v[100:101], 0
    v_exp_f32 v30, v30
    v_exp_f32 v31, v31
    v_exp_f32 v32, v32
    v_exp_f32 v33, v33
    v_mfma_f32_32x32x16_bf16 v[8:23], v[72:75], v[88:91], v[8:23]
    v_exp_f32 v34, v34
    v_exp_f32 v35, v35
    v_exp_f32 v36, v36
    v_exp_f32 v37, v37
    v_smfmac_f32_32x32x32_bf16 v[56:71], v[80:83], v[24:31], v118
    ds_read_b64_tr_b16 v[80:81], v114 offset:11776
    ds_read_b64_tr_b16 v[82:83], v115 offset:11776
    v_exp_f32 v38, v38
    v_exp_f32 v39, v39
    s_nop 2
    v_exp_f32 v8, v8
    v_exp_f32_e64 v9, v9
    v_smfmac_f32_32x32x32_bf16 v[56:71], v[84:87], v[32:39], v118
    ds_read_b64_tr_b16 v[84:85], v116 offset:11776
    ds_read_b64_tr_b16 v[86:87], v117 offset:11776
    v_exp_f32 v10, v10
    v_exp_f32 v11, v11
    v_exp_f32 v12, v12
    v_exp_f32 v13, v13
    v_mfma_f32_32x32x8_bf16 v[24:39], v[76:77], v[108:109], 0
    v_exp_f32 v14, v14
    v_exp_f32 v15, v15
    v_exp_f32 v16, v16
    v_exp_f32 v17, v17
    v_mfma_f32_32x32x16_bf16 v[24:39], v[72:75], v[92:95], v[24:39]
    ds_read_b128 v[72:75], v112 offset:3072
    v_exp_f32 v18, v18
    v_exp_f32 v19, v19
    v_exp_f32 v20, v20
    v_exp_f32_e64 v21, v21
    s_waitcnt lgkmcnt(3)
    v_smfmac_f32_32x32x32_bf16 v[40:55], v[80:83], v[8:15], v118
    v_exp_f32 v22, v22
    v_exp_f32 v23, v23
    s_nop 2
    v_exp_f32 v24, v24
    s_waitcnt lgkmcnt(0)
    s_cmp_lg_u32 s3, 0
    s_cbranch_scc1 L_nopw_95
    s_mov_b32 s31, 524288
    s_branch L_pollchk_97
L_poll_96:
    buffer_load_dwordx4 v[120:123], v119, s[52:55], 0 offen offset:2048 sc1
L_pollchk_97:
    s_waitcnt vmcnt(0)
    v_xor_b32 v120, s30, v120
    v_xor_b32 v121, s30, v121
    v_xor_b32 v122, s30, v122
    v_xor_b32 v123, s30, v123
    v_or3_b32 v120, v120, v121, v122
    v_or_b32 v120, v120, v123
    v_cmp_ne_u32 vcc, 0, v120
    s_cbranch_vccz L_polld_98
    s_sleep 6
    s_sub_u32 s31, s31, 1
    s_cbranch_scc0 L_poll_96
L_polld_98:
    v_mov_b32 v4, 163328
    v_mov_b32 v5, 1
    s_mov_b64 exec, 1
    ds_add_u32 v4, v5 offset:68
    s_mov_b64 exec, -1
L_nopw_95:
    .p2align 3
    v_smfmac_f32_32x32x32_bf16 v[40:55], v[84:87], v[16:23], v118
    v_exp_f32 v25, v25
    v_exp_f32 v26, v26
    v_exp_f32 v27, v27
    v_exp_f32 v28, v28
    v_exp_f32_e64 v29, v29
    v_mfma_f32_32x32x8_bf16 v[8:23], v[76:77], v[102:103], 0
    v_exp_f32 v30, v30
    v_exp_f32 v31, v31
    v_exp_f32 v32, v32
    v_exp_f32 v33, v33
    v_mfma_f32_32x32x16_bf16 v[8:23], v[72:75], v[88:91], v[8:23]
    v_exp_f32 v34, v34
    v_exp_f32 v35, v35
    v_exp_f32 v36, v36
    v_exp_f32 v37, v37
    v_smfmac_f32_32x32x32_bf16 v[56:71], v[80:83], v[24:31], v118
    ds_read_b64_tr_b16 v[80:81], v114 offset:13056
    ds_read_b64_tr_b16 v[82:83], v115 offset:13056
    v_exp_f32 v38, v38
    v_exp_f32 v39, v39
    s_nop 2
    v_exp_f32 v8, v8
    v_exp_f32_e64 v9, v9
    v_smfmac_f32_32x32x32_bf16 v[56:71], v[84:87], v[32:39], v118
    ds_read_b64_tr_b16 v[84:85], v116 offset:13056
    ds_read_b64_tr_b16 v[86:87], v117 offset:13056
    v_exp_f32 v10, v10
    v_exp_f32 v11, v11
    v_exp_f32 v12, v12
    v_exp_f32 v13, v13
    v_mfma_f32_32x32x8_bf16 v[24:39], v[76:77], v[110:111], 0
    v_exp_f32 v14, v14
    v_exp_f32 v15, v15
    v_exp_f32 v16, v16
    v_exp_f32 v17, v17
    v_mfma_f32_32x32x16_bf16 v[24:39], v[72:75], v[92:95], v[24:39]
    ds_read_b128 v[72:75], v112 offset:4096
    v_exp_f32 v18, v18
    v_exp_f32 v19, v19
    v_exp_f32 v20, v20
    v_exp_f32_e64 v21, v21
    s_waitcnt lgkmcnt(3)
    v_smfmac_f32_32x32x32_bf16 v[40:55], v[80:83], v[8:15], v118
    v_exp_f32 v22, v22
    v_exp_f32 v23, v23
    s_nop 2
    v_exp_f32 v24, v24
    s_waitcnt lgkmcnt(0)
    s_cmp_ge_u32 s3, 9
    s_cbranch_scc1 L_pfa_99
    v_mov_b32 v4, 163328
    s_mov_b32 s31, 524288
L_lspin_101:
    ds_read_b32 v5, v4 offset:68
    s_waitcnt lgkmcnt(0)
    v_readfirstlane_b32 s8, v5
    s_cmp_ge_u32 s8, 1
    s_cbranch_scc1 L_lsdone_102
    s_sleep 1
    s_sub_u32 s31, s31, 1
    s_cbranch_scc0 L_lspin_101
L_lsdone_102:
    s_mul_i32 s8, s81, 9
    s_add_u32 s8, s8, s3
    s_lshl_b32 m0, s3, 13
    s_mul_i32 s8, s8, 18432
    s_add_u32 s8, s8, 12259328
    buffer_load_dwordx4 v119, s[52:55], s8 offen offset:0 sc1 lds
    buffer_load_dwordx4 v119, s[52:55], s8 offen offset:1024 sc1 lds
    buffer_load_dwordx4 v119, s[52:55], s8 offen offset:2048 sc1 lds
    buffer_load_dwordx4 v119, s[52:55], s8 offen offset:3072 sc1 lds
    s_add_u32 m0, m0, 4096
    s_add_u32 s8, s8, 4096
    buffer_load_dwordx4 v119, s[52:55], s8 offen offset:0 sc1 lds
    buffer_load_dwordx4 v119, s[52:55], s8 offen offset:1024 sc1 lds
    buffer_load_dwordx4 v119, s[52:55], s8 offen offset:2048 sc1 lds
    buffer_load_dwordx4 v119, s[52:55], s8 offen offset:3072 sc1 lds
    v_lshrrev_b32 v4, 2, v1
    v_lshlrev_b32 v4, 12, v4
    v_and_b32 v5, 3, v1
    v_lshl_add_u32 v4, v5, 4, v4
    s_mul_i32 s8, s81, 9
    s_add_u32 s8, s8, s3
    s_lshl_b32 s8, s8, 16
    s_lshl_b32 s9, s80, 6
    s_add_u32 s8, s8, s9
    s_add_u32 s8, s8, 9900032
    s_lshl_b32 s15, s3, 10
    s_add_u32 s9, s15, 151552
    s_add_u32 s15, s15, 73728
    s_cmp_ge_u32 s3, 4
    s_cselect_b32 s15, s9, s15
    s_mov_b32 m0, s15
    s_nop 0
    buffer_load_dwordx4 v4, s[52:55], s8 offen sc1 lds
L_pfa_99:
    .p2align 3
    v_smfmac_f32_32x32x32_bf16 v[40:55], v[84:87], v[16:23], v118
    v_exp_f32 v25, v25
    v_exp_f32 v26, v26
    v_exp_f32 v27, v27
    v_exp_f32 v28, v28
    v_exp_f32_e64 v29, v29
    v_mfma_f32_32x32x8_bf16 v[8:23], v[78:79], v[96:97], 0
    v_exp_f32 v30, v30
    v_exp_f32 v31, v31
    v_exp_f32 v32, v32
    v_exp_f32 v33, v33
    v_mfma_f32_32x32x16_bf16 v[8:23], v[72:75], v[88:91], v[8:23]
    v_exp_f32 v34, v34
    v_exp_f32 v35, v35
    v_exp_f32 v36, v36
    v_exp_f32 v37, v37
    v_smfmac_f32_32x32x32_bf16 v[56:71], v[80:83], v[24:31], v118
    ds_read_b64_tr_b16 v[80:81], v114 offset:14336
    ds_read_b64_tr_b16 v[82:83], v115 offset:14336
    v_exp_f32 v38, v38
    v_exp_f32 v39, v39
    s_nop 2
    v_exp_f32 v8, v8
    v_exp_f32_e64 v9, v9
    v_smfmac_f32_32x32x32_bf16 v[56:71], v[84:87], v[32:39], v118
    ds_read_b64_tr_b16 v[84:85], v116 offset:14336
    ds_read_b64_tr_b16 v[86:87], v117 offset:14336
    v_exp_f32 v10, v10
    v_exp_f32 v11, v11
    v_exp_f32 v12, v12
    v_exp_f32 v13, v13
    v_mfma_f32_32x32x8_bf16 v[24:39], v[78:79], v[104:105], 0
    v_exp_f32 v14, v14
    v_exp_f32 v15, v15
    v_exp_f32 v16, v16
    v_exp_f32 v17, v17
    v_mfma_f32_32x32x16_bf16 v[24:39], v[72:75], v[92:95], v[24:39]
    ds_read_b128 v[72:75], v112 offset:5120
    v_exp_f32 v18, v18
    v_exp_f32 v19, v19
    v_exp_f32 v20, v20
    v_exp_f32_e64 v21, v21
    s_waitcnt lgkmcnt(3)
    v_smfmac_f32_32x32x32_bf16 v[40:55], v[80:83], v[8:15], v118
    v_exp_f32 v22, v22
    v_exp_f32 v23, v23
    s_nop 2
    v_exp_f32 v24, v24
    s_waitcnt lgkmcnt(0)
    s_mul_i32 s11, s6, 4864
    s_add_u32 s11, s11, 77824
    s_lshl_b32 s82, s7, 2
    s_add_u32 s82, s82, 163328
    s_lshl_b32 s83, s6, 2
    s_add_u32 s83, s83, 163328
    v_add_u32 v120, s11, v119
    v_lshl_add_u32 v121, v1, 3, s11
    v_lshl_add_u32 v122, v1, 2, s11
    v_mov_b32 v123, s83
    v_lshrrev_b32 v124, 5, v1
    v_mul_u32_u24 v124, 36736, v124
    v_lshl_add_u32 v124, v1, 2, v124
    s_lshl_b32 s60, s13, 5
    s_add_u32 s60, s60, s4
    s_lshl_b32 s60, s60, 7
    s_add_u32 s60, s60, 69632
    s_mul_i32 s61, s13, 73728
    s_add_u32 s61, s61, 7540736
    s_lshl_b32 s8, s4, 7
    s_add_u32 s65, s61, s8
    s_add_u32 s65, s65, 32768
    s_lshl_b32 s8, s4, 10
    s_add_u32 s61, s61, s8
    s_add_u32 s66, s61, 36864
    s_mov_b32 s76, -1
    s_mov_b32 s77, 0
    .p2align 3
    v_smfmac_f32_32x32x32_bf16 v[40:55], v[84:87], v[16:23], v118
    v_exp_f32 v25, v25
    v_exp_f32 v26, v26
    v_exp_f32 v27, v27
    v_exp_f32 v28, v28
    v_exp_f32_e64 v29, v29
    v_mfma_f32_32x32x8_bf16 v[8:23], v[78:79], v[98:99], 0
    v_exp_f32 v30, v30
    v_exp_f32 v31, v31
    v_exp_f32 v32, v32
    v_exp_f32 v33, v33
    v_mfma_f32_32x32x16_bf16 v[8:23], v[72:75], v[88:91], v[8:23]
    v_exp_f32 v34, v34
    v_exp_f32 v35, v35
    v_exp_f32 v36, v36
    v_exp_f32 v37, v37
    v_smfmac_f32_32x32x32_bf16 v[56:71], v[80:83], v[24:31], v118
    ds_read_b64_tr_b16 v[80:81], v114 offset:15616
    ds_read_b64_tr_b16 v[82:83], v115 offset:15616
    v_exp_f32 v38, v38
    v_exp_f32 v39, v39
    s_nop 2
    v_exp_f32 v8, v8
    v_exp_f32 v9, v9
    s_setprio 1
    v_smfmac_f32_32x32x32_bf16 v[56:71], v[84:87], v[32:39], v118
    ds_read_b64_tr_b16 v[84:85], v116 offset:15616
    ds_read_b64_tr_b16 v[86:87], v117 offset:15616
    v_exp_f32 v10, v10
    v_exp_f32 v11, v11
    v_exp_f32 v12, v12
    v_exp_f32 v13, v13
    v_mfma_f32_32x32x8_bf16 v[24:39], v[78:79], v[106:107], 0
    v_exp_f32 v14, v14
    v_exp_f32 v15, v15
    v_exp_f32 v16, v16
    v_exp_f32 v17, v17
    v_mfma_f32_32x32x16_bf16 v[24:39], v[72:75], v[92:95], v[24:39]
    ds_read_b128 v[72:75], v112 offset:6144
    v_exp_f32 v18, v18
    v_exp_f32 v19, v19
    v_exp_f32 v20, v20
    v_exp_f32_e64 v21, v21
    s_waitcnt lgkmcnt(3)
    v_smfmac_f32_32x32x32_bf16 v[40:55], v[80:83], v[8:15], v118
    v_exp_f32 v22, v22
    v_exp_f32 v23, v23
    s_nop 2
    v_exp_f32_e64 v24, v24
    s_waitcnt lgkmcnt(0)
    v_smfmac_f32_32x32x32_bf16 v[40:55], v[84:87], v[16:23], v118
    v_exp_f32 v25, v25
    v_exp_f32 v26, v26
    v_exp_f32 v27, v27
    v_exp_f32 v28, v28
    v_exp_f32_e64 v29, v29
    v_mfma_f32_32x32x8_bf16 v[8:23], v[78:79], v[100:101], 0
    v_exp_f32 v30, v30
    v_exp_f32 v31, v31
    v_exp_f32 v32, v32
    v_exp_f32 v33, v33
    v_mfma_f32_32x32x16_bf16 v[8:23], v[72:75], v[88:91], v[8:23]
    v_exp_f32 v34, v34
    v_exp_f32 v35, v35
    v_exp_f32 v36, v36
    v_exp_f32 v37, v37
    v_smfmac_f32_32x32x32_bf16 v[56:71], v[80:83], v[24:31], v118
    ds_read_b64_tr_b16 v[80:81], v114 offset:16896
    ds_read_b64_tr_b16 v[82:83], v115 offset:16896
    v_exp_f32 v38, v38
    v_exp_f32 v39, v39
    s_nop 2
    v_exp_f32 v8, v8
    v_exp_f32_e64 v9, v9
    v_smfmac_f32_32x32x32_bf16 v[56:71], v[84:87], v[32:39], v118
    ds_read_b64_tr_b16 v[84:85], v116 offset:16896
    ds_read_b64_tr_b16 v[86:87], v117 offset:16896
    v_exp_f32 v10, v10
    v_exp_f32 v11, v11
    v_exp_f32 v12, v12
    v_exp_f32 v13, v13
    v_mfma_f32_32x32x8_bf16 v[24:39], v[78:79], v[108:109], 0
    v_exp_f32 v14, v14
    v_exp_f32 v15, v15
    v_exp_f32 v16, v16
    v_exp_f32 v17, v17
    v_mfma_f32_32x32x16_bf16 v[24:39], v[72:75], v[92:95], v[24:39]
    ds_read_b128 v[72:75], v112 offset:7168
    v_exp_f32 v18, v18
    v_exp_f32 v19, v19
    v_exp_f32 v20, v20
    v_exp_f32_e64 v21, v21
    s_waitcnt lgkmcnt(3)
    v_smfmac_f32_32x32x32_bf16 v[40:55], v[80:83], v[8:15], v118
    v_exp_f32 v22, v22
    v_exp_f32 v23, v23
    s_nop 2
    v_exp_f32_e64 v24, v24
    s_waitcnt lgkmcnt(0)
    v_smfmac_f32_32x32x32_bf16 v[40:55], v[84:87], v[16:23], v118
    v_exp_f32 v25, v25
    v_exp_f32 v26, v26
    v_exp_f32 v27, v27
    v_exp_f32 v28, v28
    v_exp_f32_e64 v29, v29
    v_mfma_f32_32x32x8_bf16 v[8:23], v[78:79], v[102:103], 0
    v_exp_f32 v30, v30
    v_exp_f32 v31, v31
    v_exp_f32 v32, v32
    v_exp_f32 v33, v33
    v_mfma_f32_32x32x16_bf16 v[8:23], v[72:75], v[88:91], v[8:23]
    v_exp_f32 v34, v34
    v_exp_f32 v35, v35
    v_exp_f32 v36, v36
    v_exp_f32 v37, v37
    v_smfmac_f32_32x32x32_bf16 v[56:71], v[80:83], v[24:31], v118
    ds_read_b64_tr_b16 v[80:81], v114 offset:18176
    ds_read_b64_tr_b16 v[82:83], v115 offset:18176
    v_exp_f32 v38, v38
    v_exp_f32 v39, v39
    s_nop 2
    v_exp_f32 v8, v8
    v_exp_f32_e64 v9, v9
    v_smfmac_f32_32x32x32_bf16 v[56:71], v[84:87], v[32:39], v118
    ds_read_b64_tr_b16 v[84:85], v116 offset:18176
    ds_read_b64_tr_b16 v[86:87], v117 offset:18176
    v_exp_f32 v10, v10
    v_exp_f32 v11, v11
    v_exp_f32 v12, v12
    v_exp_f32 v13, v13
    v_mfma_f32_32x32x8_bf16 v[24:39], v[78:79], v[110:111], 0
    v_exp_f32 v14, v14
    v_exp_f32 v15, v15
    v_exp_f32 v16, v16
    v_exp_f32 v17, v17
    v_mfma_f32_32x32x16_bf16 v[24:39], v[72:75], v[92:95], v[24:39]
    s_nop 0
    v_exp_f32 v18, v18
    v_exp_f32 v19, v19
    v_exp_f32 v20, v20
    v_exp_f32 v21, v21
    s_waitcnt lgkmcnt(2)
    v_smfmac_f32_32x32x32_bf16 v[40:55], v[80:83], v[8:15], v118
    v_exp_f32 v22, v22
    v_exp_f32 v23, v23
    s_nop 2
    v_exp_f32_e64 v24, v24
    s_waitcnt lgkmcnt(0)
    v_smfmac_f32_32x32x32_bf16 v[40:55], v[84:87], v[16:23], v118
    ds_read_b32 v75, v123 offset:96
    ds_read_b64 v[72:73], v121 offset:4096
    ds_read_b32 v74, v122 offset:4608
    ds_read_b128 v[8:11], v120
    ds_read_b128 v[12:15], v120 offset:1024
    ds_read_b128 v[16:19], v120 offset:2048
    ds_read_b128 v[20:23], v120 offset:3072
    .p2align 3
    v_exp_f32 v25, v25
    v_exp_f32 v26, v26
    v_exp_f32 v27, v27
    v_exp_f32 v28, v28
    v_exp_f32 v29, v29
    v_exp_f32 v30, v30
    v_exp_f32 v31, v31
    v_exp_f32 v32, v32
    v_exp_f32 v33, v33
    v_exp_f32 v34, v34
    v_exp_f32 v35, v35
    v_exp_f32 v36, v36
    v_exp_f32_e64 v37, v37
    v_smfmac_f32_32x32x32_bf16 v[56:71], v[80:83], v[24:31], v118
    v_exp_f32 v38, v38
    v_exp_f32_e64 v39, v39
    s_nop 1
    v_smfmac_f32_32x32x32_bf16 v[56:71], v[84:87], v[32:39], v118
    s_setprio 3
    s_cmp_eq_u32 s7, 0
    s_cbranch_scc1 L_first_106
    s_waitcnt lgkmcnt(0)
    v_cmp_gt_u32 vcc, s7, v75
    s_cbranch_vccnz L_re_108
L_ok_109:
    v_pk_add_f32 v[40:41], v[40:41], v[8:9]
    v_pk_add_f32 v[42:43], v[42:43], v[10:11]
    v_pk_add_f32 v[44:45], v[44:45], v[12:13]
    v_pk_add_f32 v[46:47], v[46:47], v[14:15]
    s_nop 2
    v_permlane32_swap_b32 v50, v66
    v_permlane32_swap_b32 v48, v64
    v_permlane32_swap_b32 v49, v65
    s_nop 0
    v_add_f32 v50, v50, v74
    v_pk_add_f32 v[48:49], v[48:49], v[72:73]
    v_mov_b32 v66, v50
    v_pk_add_f32 v[56:57], v[56:57], v[16:17]
    v_pk_add_f32 v[58:59], v[58:59], v[18:19]
    v_pk_add_f32 v[60:61], v[60:61], v[20:21]
    v_pk_add_f32 v[62:63], v[62:63], v[22:23]
    s_cmp_eq_u32 s7, 3
    s_cbranch_scc1 L_fin_103
    s_branch L_wr_107
L_re_108:
    v_mov_b32 v4, s83
    s_mov_b32 s31, 524288
L_lspin_110:
    ds_read_b32 v5, v4 offset:96
    s_waitcnt lgkmcnt(0)
    v_readfirstlane_b32 s8, v5
    s_cmp_ge_u32 s8, s7
    s_cbranch_scc1 L_lsdone_111
    s_sleep 1
    s_sub_u32 s31, s31, 1
    s_cbranch_scc0 L_lspin_110
L_lsdone_111:
    ds_read_b32 v75, v123 offset:96
    ds_read_b64 v[72:73], v121 offset:4096
    ds_read_b32 v74, v122 offset:4608
    ds_read_b128 v[8:11], v120
    ds_read_b128 v[12:15], v120 offset:1024
    ds_read_b128 v[16:19], v120 offset:2048
    ds_read_b128 v[20:23], v120 offset:3072
    s_waitcnt lgkmcnt(0)
    s_branch L_ok_109
L_first_106:
    v_mov_b32 v4, s82
    v_mov_b32 v5, 1
    s_mov_b64 exec, 1
    ds_add_u32 v4, v5 offset:80
    s_mov_b64 exec, -1
    v_mov_b32 v4, s82
    s_mov_b32 s31, 524288
L_lspin_112:
    ds_read_b32 v5, v4 offset:80
    s_waitcnt lgkmcnt(0)
    v_readfirstlane_b32 s8, v5
    s_cmp_ge_u32 s8, 4
    s_cbranch_scc1 L_lsdone_113
    s_sleep 1
    s_sub_u32 s31, s31, 1
    s_cbranch_scc0 L_lspin_112
L_lsdone_113:
    v_permlane32_swap_b32 v50, v66
    v_permlane32_swap_b32 v48, v64
    v_permlane32_swap_b32 v49, v65
    s_nop 0
L_wr_107:
    ds_write_b128 v120, v[40:43]
    ds_write_b128 v120, v[44:47] offset:1024
    ds_write_b128 v120, v[56:59] offset:2048
    ds_write_b128 v120, v[60:63] offset:3072
    ds_write_b64 v121, v[48:49] offset:4096
    ds_write_b32 v122, v50 offset:4608
    v_mov_b32 v4, s83
    v_mov_b32 v5, 1
    s_mov_b64 exec, 1
    ds_add_u32 v4, v5 offset:96
    s_mov_b64 exec, -1
    v_mov_b32 v4, s82
    v_mov_b32 v5, 1
    s_mov_b64 exec, 1
    ds_add_u32 v4, v5 offset:80
    s_mov_b64 exec, -1
    s_setprio 0
    s_cmp_ge_u32 s3, 9
    s_cbranch_scc1 L_p9_104
    v_and_b32 v6, 15, v1
    v_lshlrev_b32 v6, 2, v6
    s_lshl_b32 s8, s80, 7
    s_add_u32 s8, s8, 12922880
    s_waitcnt lgkmcnt(0)
    buffer_load_dword v116, v6, s[52:55], s8 offen sc1
    buffer_load_dword v117, v6, s[52:55], s8 offen offset:64 sc1
    s_mul_i32 s14, s81, 9
    s_add_u32 s14, s14, s3
    s_mul_i32 s8, s14, 18432
    s_add_u32 s8, s8, 12267520
    buffer_load_dwordx4 v[72:75], v119, s[52:55], s8 offen offset:0 sc1
    buffer_load_dwordx4 v[76:79], v119, s[52:55], s8 offen offset:1024 sc1
    buffer_load_dwordx4 v[80:83], v119, s[52:55], s8 offen offset:2048 sc1
    buffer_load_dwordx4 v[84:87], v119, s[52:55], s8 offen offset:3072 sc1
    s_add_u32 s8, s8, 4096
    buffer_load_dwordx4 v[88:91], v119, s[52:55], s8 offen offset:0 sc1
    buffer_load_dwordx4 v[92:95], v119, s[52:55], s8 offen offset:1024 sc1
    buffer_load_dwordx4 v[96:99], v119, s[52:55], s8 offen offset:2048 sc1
    buffer_load_dwordx4 v[100:103], v119, s[52:55], s8 offen offset:3072 sc1
    s_add_u32 s8, s8, 4096
    buffer_load_dwordx4 v[104:107], v119, s[52:55], s8 offen offset:0 sc1
    buffer_load_dwordx4 v[108:111], v119, s[52:55], s8 offen offset:1024 sc1
    s_lshl_b32 s8, s3, 13
    v_add_u32 v4, s8, v119
    v_lshrrev_b32 v5, 2, v1
    v_lshlrev_b32 v5, 6, v5
    v_and_b32 v6, 3, v1
    v_lshl_add_u32 v5, v6, 3, v5
    v_add_u32 v5, s15, v5
    s_waitcnt vmcnt(10)
    ds_read_b128 v[8:11], v4 offset:0
    ds_read_b128 v[12:15], v4 offset:1024
    ds_read_b128 v[16:19], v4 offset:2048
    ds_read_b128 v[20:23], v4 offset:3072
    ds_read_b128 v[24:27], v4 offset:4096
    ds_read_b128 v[28:31], v4 offset:5120
    ds_read_b128 v[32:35], v4 offset:6144
    ds_read_b128 v[36:39], v4 offset:7168
    ds_read_b64_tr_b16 v[112:113], v5
    ds_read_b64_tr_b16 v[114:115], v5 offset:32
    v_lshrrev_b32 v4, 4, v1
    v_and_b32 v6, 15, v1
    v_lshlrev_b32 v118, 9, v4
    v_add_u32 v118, 97280, v118
    v_lshl_add_u32 v119, v6, 2, v118
    v_add_u32 v119, 32768, v119
    v_lshl_add_u32 v118, v6, 4, v118
    v_and_b32 v7, 31, v1
    v_mul_u32_u24 v7, 1152, v7
    v_lshrrev_b32 v4, 5, v1
    v_lshl_add_u32 v7, v4, 4, v7
    v_add_u32 v6, 2048, v119
    v_cvt_pk_bf16_f32 v116, v116, v116
    v_and_b32 v116, 0xffff0000, v116
    v_mul_f32 v116, 3216550459, v116
    v_exp_f32 v116, v116
    s_nop 0
    v_add_f32 v116, 1.0, v116
    v_rcp_f32 v116, v116
    s_nop 0
    v_cvt_pk_bf16_f32 v116, v116, v116
    v_and_b32 v116, 0xffff0000, v116
    v_cvt_pk_bf16_f32 v117, v117, v117
    v_and_b32 v117, 0xffff0000, v117
    v_mul_f32 v117, 3216550459, v117
    v_exp_f32 v117, v117
    s_nop 0
    v_add_f32 v117, 1.0, v117
    v_rcp_f32 v117, v117
    s_nop 0
    v_cvt_pk_bf16_f32 v117, v117, v117
    v_and_b32 v117, 0xffff0000, v117
    v_mov_b32 v120, 0
    v_mov_b32 v121, 0
    v_mov_b32 v122, 0
    v_mov_b32 v123, 0
    v_mov_b32 v124, 0
    v_mov_b32 v125, 0
    v_mov_b32 v126, 0
    v_mov_b32 v127, 0
    s_mov_b32 s56, s38
    s_mov_b32 s57, s39
    s_mov_b32 s58, 2359296
    s_mov_b32 s59, 0x20000
    s_mul_i32 s8, s80, 36864
    s_lshl_b32 s9, s14, 5
    s_add_u32 s14, s8, s9
    v_mov_b32 v4, 163328
    s_mov_b32 s74, 0
    s_mov_b32 s31, 524288
    s_waitcnt vmcnt(0) lgkmcnt(0)
    s_branch L_scan_114
L_scan_114_s:
    s_sleep 1
L_scan_114:
    ds_read_b32 v5, v4 offset:76
    s_sub_u32 s31, s31, 1
    s_cselect_b32 s77, 0xff, 0
    s_waitcnt lgkmcnt(0)
    v_readfirstlane_b32 s75, v5
    s_or_b32 s75, s75, s77
    s_andn2_b32 s76, s75, s74
    s_cbranch_scc0 L_scan_114_s
    s_mov_b32 s74, s75
    s_cmp_eq_u32 s75, 0xff
    s_cselect_b32 s77, 0x100, 0
    s_or_b32 s76, s76, s77
L_e0:
    s_bitcmp1_b32 s76, 0
    s_cbranch_scc1 L_r0
L_e1:
    s_bitcmp1_b32 s76, 1
    s_cbranch_scc1 L_r1
L_e2:
    s_bitcmp1_b32 s76, 2
    s_cbranch_scc1 L_r2
L_e3:
    s_bitcmp1_b32 s76, 3
    s_cbranch_scc1 L_r3
L_e4:
    s_bitcmp1_b32 s76, 4
    s_cbranch_scc1 L_r4
L_e5:
    s_bitcmp1_b32 s76, 5
    s_cbranch_scc1 L_r5
L_e6:
    s_bitcmp1_b32 s76, 6
    s_cbranch_scc1 L_r6
L_e7:
    s_bitcmp1_b32 s76, 7
    s_cbranch_scc1 L_r7
L_e8:
    s_bitcmp1_b32 s76, 8
    s_cbranch_scc1 L_r8
    s_branch L_scan_114
L_r0:
    ds_read_b128 v[40:43], v118 offset:0
    ds_read_b128 v[44:47], v118 offset:256
    ds_read_b128 v[48:51], v118 offset:2048
    ds_read_b128 v[52:55], v118 offset:2304
    s_branch L_p1
L_r1:
    ds_read_b128 v[56:59], v118 offset:4096
    ds_read_b128 v[60:63], v118 offset:4352
    ds_read_b128 v[64:67], v118 offset:6144
    ds_read_b128 v[68:71], v118 offset:6400
    s_branch L_p2
L_r2:
    ds_read_b128 v[40:43], v118 offset:8192
    ds_read_b128 v[44:47], v118 offset:8448
    ds_read_b128 v[48:51], v118 offset:10240
    ds_read_b128 v[52:55], v118 offset:10496
    s_branch L_p3
L_r3:
    ds_read_b128 v[56:59], v118 offset:12288
    ds_read_b128 v[60:63], v118 offset:12544
    ds_read_b128 v[64:67], v118 offset:14336
    ds_read_b128 v[68:71], v118 offset:14592
    s_branch L_p4
L_r4:
    ds_read_b128 v[40:43], v118 offset:16384
    ds_read_b128 v[44:47], v118 offset:16640
    ds_read_b128 v[48:51], v118 offset:18432
    ds_read_b128 v[52:55], v118 offset:18688
    s_branch L_p5
L_r5:
    ds_read_b128 v[56:59], v118 offset:20480
    ds_read_b128 v[60:63], v118 offset:20736
    ds_read_b128 v[64:67], v118 offset:22528
    ds_read_b128 v[68:71], v118 offset:22784
    s_branch L_p6
L_r6:
    ds_read_b128 v[40:43], v118 offset:24576
    ds_read_b128 v[44:47], v118 offset:24832
    ds_read_b128 v[48:51], v118 offset:26624
    ds_read_b128 v[52:55], v118 offset:26880
    s_branch L_p7
L_r7:
    ds_read_b128 v[56:59], v118 offset:28672
    ds_read_b128 v[60:63], v118 offset:28928
    ds_read_b128 v[64:67], v118 offset:30720
    ds_read_b128 v[68:71], v118 offset:30976
    s_branch L_p8
L_r8:
    ds_read2_b32 v[40:41], v119 offset0:0 offset1:32
    ds_read2_b32 v[42:43], v119 offset0:64 offset1:96
    ds_read2_b32 v[44:45], v119 offset0:16 offset1:48
    ds_read2_b32 v[46:47], v119 offset0:80 offset1:112
    ds_read2_b32 v[48:49], v6 offset0:0 offset1:32
    ds_read2_b32 v[50:51], v6 offset0:64 offset1:96
    ds_read2_b32 v[52:53], v6 offset0:16 offset1:48
    ds_read2_b32 v[54:55], v6 offset0:80 offset1:112
    s_branch L_p9
L_f1:
    s_waitcnt lgkmcnt(3)
    v_mfma_f32_16x16x32_bf16 v[120:123], v[8:11], v[40:43], v[120:123]
    s_waitcnt lgkmcnt(2)
    v_mfma_f32_16x16x32_bf16 v[124:127], v[8:11], v[44:47], v[124:127]
    s_waitcnt lgkmcnt(1)
    v_mfma_f32_16x16x32_bf16 v[120:123], v[12:15], v[48:51], v[120:123]
    s_waitcnt lgkmcnt(0)
    v_mfma_f32_16x16x32_bf16 v[124:127], v[12:15], v[52:55], v[124:127]
    s_branch L_e2
L_f2:
    s_waitcnt lgkmcnt(3)
    v_mfma_f32_16x16x32_bf16 v[120:123], v[16:19], v[56:59], v[120:123]
    s_waitcnt lgkmcnt(2)
    v_mfma_f32_16x16x32_bf16 v[124:127], v[16:19], v[60:63], v[124:127]
    s_waitcnt lgkmcnt(1)
    v_mfma_f32_16x16x32_bf16 v[120:123], v[20:23], v[64:67], v[120:123]
    s_waitcnt lgkmcnt(0)
    v_mfma_f32_16x16x32_bf16 v[124:127], v[20:23], v[68:71], v[124:127]
    s_branch L_e3
L_f3:
    s_waitcnt lgkmcnt(3)
    v_mfma_f32_16x16x32_bf16 v[120:123], v[24:27], v[40:43], v[120:123]
    s_waitcnt lgkmcnt(2)
    v_mfma_f32_16x16x32_bf16 v[124:127], v[24:27], v[44:47], v[124:127]
    s_waitcnt lgkmcnt(1)
    v_mfma_f32_16x16x32_bf16 v[120:123], v[28:31], v[48:51], v[120:123]
    s_waitcnt lgkmcnt(0)
    v_mfma_f32_16x16x32_bf16 v[124:127], v[28:31], v[52:55], v[124:127]
    s_branch L_e4
L_f4:
    s_waitcnt lgkmcnt(3)
    v_mfma_f32_16x16x32_bf16 v[120:123], v[32:35], v[56:59], v[120:123]
    s_waitcnt lgkmcnt(2)
    v_mfma_f32_16x16x32_bf16 v[124:127], v[32:35], v[60:63], v[124:127]
    s_waitcnt lgkmcnt(1)
    v_mfma_f32_16x16x32_bf16 v[120:123], v[36:39], v[64:67], v[120:123]
    s_waitcnt lgkmcnt(0)
    v_mfma_f32_16x16x32_bf16 v[124:127], v[36:39], v[68:71], v[124:127]
    s_branch L_e5
L_f5:
    s_waitcnt lgkmcnt(3)
    v_mfma_f32_16x16x32_bf16 v[120:123], v[72:75], v[40:43], v[120:123]
    s_waitcnt lgkmcnt(2)
    v_mfma_f32_16x16x32_bf16 v[124:127], v[72:75], v[44:47], v[124:127]
    s_waitcnt lgkmcnt(1)
    v_mfma_f32_16x16x32_bf16 v[120:123], v[76:79], v[48:51], v[120:123]
    s_waitcnt lgkmcnt(0)
    v_mfma_f32_16x16x32_bf16 v[124:127], v[76:79], v[52:55], v[124:127]
    s_branch L_e6
L_f6:
    s_waitcnt lgkmcnt(3)
    v_mfma_f32_16x16x32_bf16 v[120:123], v[80:83], v[56:59], v[120:123]
    s_waitcnt lgkmcnt(2)
    v_mfma_f32_16x16x32_bf16 v[124:127], v[80:83], v[60:63], v[124:127]
    s_waitcnt lgkmcnt(1)
    v_mfma_f32_16x16x32_bf16 v[120:123], v[84:87], v[64:67], v[120:123]
    s_waitcnt lgkmcnt(0)
    v_mfma_f32_16x16x32_bf16 v[124:127], v[84:87], v[68:71], v[124:127]
    s_branch L_e7
L_f7:
    s_waitcnt lgkmcnt(3)
    v_mfma_f32_16x16x32_bf16 v[120:123], v[88:91], v[40:43], v[120:123]
    s_waitcnt lgkmcnt(2)
    v_mfma_f32_16x16x32_bf16 v[124:127], v[88:91], v[44:47], v[124:127]
    s_waitcnt lgkmcnt(1)
    v_mfma_f32_16x16x32_bf16 v[120:123], v[92:95], v[48:51], v[120:123]
    s_waitcnt lgkmcnt(0)
    v_mfma_f32_16x16x32_bf16 v[124:127], v[92:95], v[52:55], v[124:127]
    s_branch L_e8
L_f8:
    s_waitcnt lgkmcnt(3)
    v_mfma_f32_16x16x32_bf16 v[120:123], v[96:99], v[56:59], v[120:123]
    s_waitcnt lgkmcnt(2)
    v_mfma_f32_16x16x32_bf16 v[124:127], v[96:99], v[60:63], v[124:127]
    s_waitcnt lgkmcnt(1)
    v_mfma_f32_16x16x32_bf16 v[120:123], v[100:103], v[64:67], v[120:123]
    s_waitcnt lgkmcnt(0)
    v_mfma_f32_16x16x32_bf16 v[124:127], v[100:103], v[68:71], v[124:127]
    s_branch L_scan_114
L_p1:
    s_bitcmp0_b32 s76, 1
    s_cbranch_scc1 L_f1
    ds_read_b128 v[56:59], v118 offset:4096
    ds_read_b128 v[60:63], v118 offset:4352
    ds_read_b128 v[64:67], v118 offset:6144
    ds_read_b128 v[68:71], v118 offset:6400
    s_waitcnt lgkmcnt(7)
    v_mfma_f32_16x16x32_bf16 v[120:123], v[8:11], v[40:43], v[120:123]
    s_waitcnt lgkmcnt(6)
    v_mfma_f32_16x16x32_bf16 v[124:127], v[8:11], v[44:47], v[124:127]
    s_waitcnt lgkmcnt(5)
    v_mfma_f32_16x16x32_bf16 v[120:123], v[12:15], v[48:51], v[120:123]
    s_waitcnt lgkmcnt(4)
    v_mfma_f32_16x16x32_bf16 v[124:127], v[12:15], v[52:55], v[124:127]
L_p2:
    s_bitcmp0_b32 s76, 2
    s_cbranch_scc1 L_f2
    ds_read_b128 v[40:43], v118 offset:8192
    ds_read_b128 v[44:47], v118 offset:8448
    ds_read_b128 v[48:51], v118 offset:10240
    ds_read_b128 v[52:55], v118 offset:10496
    s_waitcnt lgkmcnt(7)
    v_mfma_f32_16x16x32_bf16 v[120:123], v[16:19], v[56:59], v[120:123]
    s_waitcnt lgkmcnt(6)
    v_mfma_f32_16x16x32_bf16 v[124:127], v[16:19], v[60:63], v[124:127]
    s_waitcnt lgkmcnt(5)
    v_mfma_f32_16x16x32_bf16 v[120:123], v[20:23], v[64:67], v[120:123]
    s_waitcnt lgkmcnt(4)
    v_mfma_f32_16x16x32_bf16 v[124:127], v[20:23], v[68:71], v[124:127]
L_p3:
    s_bitcmp0_b32 s76, 3
    s_cbranch_scc1 L_f3
    ds_read_b128 v[56:59], v118 offset:12288
    ds_read_b128 v[60:63], v118 offset:12544
    ds_read_b128 v[64:67], v118 offset:14336
    ds_read_b128 v[68:71], v118 offset:14592
    s_waitcnt lgkmcnt(7)
    v_mfma_f32_16x16x32_bf16 v[120:123], v[24:27], v[40:43], v[120:123]
    s_waitcnt lgkmcnt(6)
    v_mfma_f32_16x16x32_bf16 v[124:127], v[24:27], v[44:47], v[124:127]
    s_waitcnt lgkmcnt(5)
    v_mfma_f32_16x16x32_bf16 v[120:123], v[28:31], v[48:51], v[120:123]
    s_waitcnt lgkmcnt(4)
    v_mfma_f32_16x16x32_bf16 v[124:127], v[28:31], v[52:55], v[124:127]
L_p4:
    s_bitcmp0_b32 s76, 4
    s_cbranch_scc1 L_f4
    ds_read_b128 v[40:43], v118 offset:16384
    ds_read_b128 v[44:47], v118 offset:16640
    ds_read_b128 v[48:51], v118 offset:18432
    ds_read_b128 v[52:55], v118 offset:18688
    s_waitcnt lgkmcnt(7)
    v_mfma_f32_16x16x32_bf16 v[120:123], v[32:35], v[56:59], v[120:123]
    s_waitcnt lgkmcnt(6)
    v_mfma_f32_16x16x32_bf16 v[124:127], v[32:35], v[60:63], v[124:127]
    s_waitcnt lgkmcnt(5)
    v_mfma_f32_16x16x32_bf16 v[120:123], v[36:39], v[64:67], v[120:123]
    s_waitcnt lgkmcnt(4)
    v_mfma_f32_16x16x32_bf16 v[124:127], v[36:39], v[68:71], v[124:127]
L_p5:
    s_bitcmp0_b32 s76, 5
    s_cbranch_scc1 L_f5
    ds_read_b128 v[56:59], v118 offset:20480
    ds_read_b128 v[60:63], v118 offset:20736
    ds_read_b128 v[64:67], v118 offset:22528
    ds_read_b128 v[68:71], v118 offset:22784
    s_waitcnt lgkmcnt(7)
    v_mfma_f32_16x16x32_bf16 v[120:123], v[72:75], v[40:43], v[120:123]
    s_waitcnt lgkmcnt(6)
    v_mfma_f32_16x16x32_bf16 v[124:127], v[72:75], v[44:47], v[124:127]
    s_waitcnt lgkmcnt(5)
    v_mfma_f32_16x16x32_bf16 v[120:123], v[76:79], v[48:51], v[120:123]
    s_waitcnt lgkmcnt(4)
    v_mfma_f32_16x16x32_bf16 v[124:127], v[76:79], v[52:55], v[124:127]
L_p6:
    s_bitcmp0_b32 s76, 6
    s_cbranch_scc1 L_f6
    ds_read_b128 v[40:43], v118 offset:24576
    ds_read_b128 v[44:47], v118 offset:24832
    ds_read_b128 v[48:51], v118 offset:26624
    ds_read_b128 v[52:55], v118 offset:26880
    s_waitcnt lgkmcnt(7)
    v_mfma_f32_16x16x32_bf16 v[120:123], v[80:83], v[56:59], v[120:123]
    s_waitcnt lgkmcnt(6)
    v_mfma_f32_16x16x32_bf16 v[124:127], v[80:83], v[60:63], v[124:127]
    s_waitcnt lgkmcnt(5)
    v_mfma_f32_16x16x32_bf16 v[120:123], v[84:87], v[64:67], v[120:123]
    s_waitcnt lgkmcnt(4)
    v_mfma_f32_16x16x32_bf16 v[124:127], v[84:87], v[68:71], v[124:127]
L_p7:
    s_bitcmp0_b32 s76, 7
    s_cbranch_scc1 L_f7
    ds_read_b128 v[56:59], v118 offset:28672
    ds_read_b128 v[60:63], v118 offset:28928
    ds_read_b128 v[64:67], v118 offset:30720
    ds_read_b128 v[68:71], v118 offset:30976
    s_waitcnt lgkmcnt(7)
    v_mfma_f32_16x16x32_bf16 v[120:123], v[88:91], v[40:43], v[120:123]
    s_waitcnt lgkmcnt(6)
    v_mfma_f32_16x16x32_bf16 v[124:127], v[88:91], v[44:47], v[124:127]
    s_waitcnt lgkmcnt(5)
    v_mfma_f32_16x16x32_bf16 v[120:123], v[92:95], v[48:51], v[120:123]
    s_waitcnt lgkmcnt(4)
    v_mfma_f32_16x16x32_bf16 v[124:127], v[92:95], v[52:55], v[124:127]
L_p8:
    s_bitcmp0_b32 s76, 8
    s_cbranch_scc1 L_f8
    ds_read2_b32 v[40:41], v119 offset0:0 offset1:32
    ds_read2_b32 v[42:43], v119 offset0:64 offset1:96
    ds_read2_b32 v[44:45], v119 offset0:16 offset1:48
    ds_read2_b32 v[46:47], v119 offset0:80 offset1:112
    ds_read2_b32 v[48:49], v6 offset0:0 offset1:32
    ds_read2_b32 v[50:51], v6 offset0:64 offset1:96
    ds_read2_b32 v[52:53], v6 offset0:16 offset1:48
    ds_read2_b32 v[54:55], v6 offset0:80 offset1:112
    s_waitcnt lgkmcnt(11)
    v_mfma_f32_16x16x32_bf16 v[120:123], v[96:99], v[56:59], v[120:123]
    s_waitcnt lgkmcnt(10)
    v_mfma_f32_16x16x32_bf16 v[124:127], v[96:99], v[60:63], v[124:127]
    s_waitcnt lgkmcnt(9)
    v_mfma_f32_16x16x32_bf16 v[120:123], v[100:103], v[64:67], v[120:123]
    s_waitcnt lgkmcnt(8)
    v_mfma_f32_16x16x32_bf16 v[124:127], v[100:103], v[68:71], v[124:127]
L_p9:
    v_lshlrev_b32 v8, 16, v112
    v_and_b32 v9, 0xffff0000, v112
    v_lshlrev_b32 v10, 16, v113
    v_and_b32 v11, 0xffff0000, v113
    v_lshlrev_b32 v12, 16, v114
    v_and_b32 v13, 0xffff0000, v114
    v_lshlrev_b32 v14, 16, v115
    v_and_b32 v15, 0xffff0000, v115
    v_sub_f32 v16, 1.0, v116
    v_mul_f32 v8, v116, v8
    v_mul_f32 v9, v116, v9
    v_mul_f32 v10, v116, v10
    v_mul_f32 v11, v116, v11
    v_sub_f32 v17, 1.0, v117
    v_mul_f32 v12, v117, v12
    v_mul_f32 v13, v117, v13
    v_mul_f32 v14, v117, v14
    v_mul_f32 v15, v117, v15
    v_cvt_pk_bf16_f32 v16, v16, v17
    v_and_b32 v17, 0xffff0000, v16
    v_lshlrev_b32 v16, 16, v16
    s_waitcnt lgkmcnt(6)
    v_mfma_f32_16x16x32_bf16 v[120:123], v[104:107], v[40:43], v[120:123]
    s_waitcnt lgkmcnt(4)
    v_mfma_f32_16x16x32_bf16 v[124:127], v[104:107], v[44:47], v[124:127]
    s_waitcnt lgkmcnt(2)
    v_mfma_f32_16x16x32_bf16 v[120:123], v[108:111], v[48:51], v[120:123]
    s_waitcnt lgkmcnt(0)
    v_mfma_f32_16x16x32_bf16 v[124:127], v[108:111], v[52:55], v[124:127]
    s_nop 5
    v_fmac_f32 v8, v16, v120
    v_fmac_f32 v9, v16, v121
    v_fmac_f32 v10, v16, v122
    v_fmac_f32 v11, v16, v123
    v_cvt_pk_bf16_f32 v20, v8, v9
    v_cvt_pk_bf16_f32 v21, v10, v11
    v_fmac_f32 v12, v17, v124
    v_fmac_f32 v13, v17, v125
    v_fmac_f32 v14, v17, v126
    v_fmac_f32 v15, v17, v127
    v_cvt_pk_bf16_f32 v22, v12, v13
    v_cvt_pk_bf16_f32 v23, v14, v15
    s_nop 1
    v_permlane16_swap_b32 v20, v22
    v_permlane16_swap_b32 v21, v23
    s_nop 0
    buffer_store_dwordx4 v[20:23], v7, s[56:59], s14 offen
    s_branch L_end_105
L_p9_104:
    v_mov_b32 v4, 163328
    s_mov_b32 s31, 524288
L_lspin_118:
    ds_read_b32 v5, v4 offset:84
    s_waitcnt lgkmcnt(0)
    v_readfirstlane_b32 s8, v5
    s_cmp_ge_u32 s8, 4
    s_cbranch_scc1 L_lsdone_119
    s_sleep 1
    s_sub_u32 s31, s31, 1
    s_cbranch_scc0 L_lspin_118
L_lsdone_119:
    v_mov_b32 v4, 163328
    s_mov_b32 s31, 524288
L_lspin_120:
    ds_read_b32 v5, v4 offset:88
    s_waitcnt lgkmcnt(0)
    v_readfirstlane_b32 s8, v5
    s_cmp_ge_u32 s8, 4
    s_cbranch_scc1 L_lsdone_121
    s_sleep 1
    s_sub_u32 s31, s31, 1
    s_cbranch_scc0 L_lspin_120
L_lsdone_121:
    s_setprio 3
    s_sub_u32 s77, s3, 9
    s_mul_i32 s77, s77, 3
    s_lshl_b32 s8, s77, 2
    v_add_u32 v6, s8, v1
    s_lshr_b32 s8, s80, 1
    s_lshl_b32 s8, s8, 12
    s_add_u32 s8, s8, 69632
    v_lshl_add_u32 v6, v6, 7, s8
    s_cmp_eq_u32 s77, 6
    s_movk_i32 s74, 0xfff
    s_cselect_b32 s74, 0xff, s74
    s_mov_b32 s75, 0
    s_mul_i32 s78, s80, 36864
    s_add_u32 s78, s78, 7540736
    v_mov_b32 v4, 163328
    s_mov_b32 s31, 524288
L_pl_115:
    s_mov_b32 exec_lo, s74
    s_mov_b32 exec_hi, 0
    buffer_load_dword v7, v6, s[52:55], 0 offen sc1
    s_cmp_eq_u32 s75, 0
    s_cbranch_scc1 L_pd_117
    s_mov_b64 exec, 1
    s_waitcnt vmcnt(1)
    ds_or_b32 v4, v5 offset:76
    s_mov_b32 exec_lo, s74
L_pd_117:
    s_waitcnt vmcnt(0)
    v_cmp_ne_u32 vcc, s30, v7
    s_mov_b64 exec, -1
    s_sub_u32 s31, s31, 1
    s_cselect_b32 vcc_lo, 0, vcc_lo
    s_orn2_b32 s76, vcc_lo, s74
    s_mov_b32 s75, 0
    s_and_b32 s8, s76, 15
    s_cbranch_scc1 L_og_122
    s_andn2_b32 s74, s74, 15
    s_add_u32 s8, s77, 0
    s_bitset1_b32 s75, s8
    s_lshl_b32 s9, s8, 12
    s_add_u32 m0, s9, 97280
    s_add_u32 s9, s9, s78
    buffer_load_dwordx4 v119, s[52:55], s9 offen offset:0 sc1 lds
    buffer_load_dwordx4 v119, s[52:55], s9 offen offset:1024 sc1 lds
    buffer_load_dwordx4 v119, s[52:55], s9 offen offset:2048 sc1 lds
    buffer_load_dwordx4 v119, s[52:55], s9 offen offset:3072 sc1 lds
    s_lshl_b32 s9, s8, 9
    s_add_u32 m0, s9, 130048
    s_add_u32 s9, s9, s78
    s_add_u32 s9, s9, 32768
    s_mov_b64 exec, 0xffffffff
    buffer_load_dwordx4 v119, s[52:55], s9 offen sc1 lds
    s_mov_b64 exec, -1
L_og_122:
    s_and_b32 s8, s76, 240
    s_cbranch_scc1 L_og_123
    s_andn2_b32 s74, s74, 240
    s_add_u32 s8, s77, 1
    s_bitset1_b32 s75, s8
    s_lshl_b32 s9, s8, 12
    s_add_u32 m0, s9, 97280
    s_add_u32 s9, s9, s78
    buffer_load_dwordx4 v119, s[52:55], s9 offen offset:0 sc1 lds
    buffer_load_dwordx4 v119, s[52:55], s9 offen offset:1024 sc1 lds
    buffer_load_dwordx4 v119, s[52:55], s9 offen offset:2048 sc1 lds
    buffer_load_dwordx4 v119, s[52:55], s9 offen offset:3072 sc1 lds
    s_lshl_b32 s9, s8, 9
    s_add_u32 m0, s9, 130048
    s_add_u32 s9, s9, s78
    s_add_u32 s9, s9, 32768
    s_mov_b64 exec, 0xffffffff
    buffer_load_dwordx4 v119, s[52:55], s9 offen sc1 lds
    s_mov_b64 exec, -1
L_og_123:
    s_and_b32 s8, s76, 3840
    s_cbranch_scc1 L_og_124
    s_andn2_b32 s74, s74, 3840
    s_add_u32 s8, s77, 2
    s_bitset1_b32 s75, s8
    s_lshl_b32 s9, s8, 12
    s_add_u32 m0, s9, 97280
    s_add_u32 s9, s9, s78
    buffer_load_dwordx4 v119, s[52:55], s9 offen offset:0 sc1 lds
    buffer_load_dwordx4 v119, s[52:55], s9 offen offset:1024 sc1 lds
    buffer_load_dwordx4 v119, s[52:55], s9 offen offset:2048 sc1 lds
    buffer_load_dwordx4 v119, s[52:55], s9 offen offset:3072 sc1 lds
    s_lshl_b32 s9, s8, 9
    s_add_u32 m0, s9, 130048
    s_add_u32 s9, s9, s78
    s_add_u32 s9, s9, 32768
    s_mov_b64 exec, 0xffffffff
    buffer_load_dwordx4 v119, s[52:55], s9 offen sc1 lds
    s_mov_b64 exec, -1
L_og_124:
    s_cmp_eq_u32 s75, 0
    s_cbranch_scc1 L_pc_116
    v_mov_b32 v5, s75
    s_cmp_eq_u32 s74, 0
    s_cbranch_scc0 L_pl_115
    s_mov_b64 exec, 1
    s_waitcnt vmcnt(0)
    ds_or_b32 v4, v5 offset:76
    s_mov_b64 exec, -1
    s_branch L_end_105
L_pc_116:
    s_sleep 3
    s_branch L_pl_115
L_fin_103:
    v_permlane32_swap_b32 v50, v66
    s_nop 0
    v_rcp_f32 v4, v50
    v_rcp_f32 v6, v66
    v_pk_mul_f32 v[40:41], v[40:41], v[4:5] op_sel_hi:[1,0]
    v_pk_mul_f32 v[42:43], v[42:43], v[4:5] op_sel_hi:[1,0]
    v_pk_mul_f32 v[44:45], v[44:45], v[4:5] op_sel_hi:[1,0]
    v_pk_mul_f32 v[46:47], v[46:47], v[4:5] op_sel_hi:[1,0]
    v_cvt_pk_bf16_f32 v8, v40, v41
    v_cvt_pk_bf16_f32 v9, v42, v43
    v_cvt_pk_bf16_f32 v10, v44, v45
    v_cvt_pk_bf16_f32 v11, v46, v47
    buffer_store_dwordx4 v[8:11], v119, s[52:55], s61 offen sc1
    v_pk_mul_f32 v[56:57], v[56:57], v[6:7] op_sel_hi:[1,0]
    v_pk_mul_f32 v[58:59], v[58:59], v[6:7] op_sel_hi:[1,0]
    v_pk_mul_f32 v[60:61], v[60:61], v[6:7] op_sel_hi:[1,0]
    v_pk_mul_f32 v[62:63], v[62:63], v[6:7] op_sel_hi:[1,0]
    v_cndmask_b32 v4, v6, v4, s[76:77]
    v_cvt_pk_bf16_f32 v12, v56, v57
    v_cvt_pk_bf16_f32 v13, v58, v59
    v_cvt_pk_bf16_f32 v14, v60, v61
    v_cvt_pk_bf16_f32 v15, v62, v63
    buffer_store_dwordx4 v[12:15], v119, s[52:55], s66 offen sc1
    v_pk_mul_f32 v[48:49], v[48:49], v[4:5] op_sel_hi:[1,0]
    v_cvt_pk_bf16_f32 v16, v48, v49
    buffer_store_dword v16, v124, s[52:55], s65 offen sc1
    v_mov_b32 v4, s82
    v_mov_b32 v5, 1
    s_mov_b64 exec, 1
    ds_add_u32 v4, v5 offset:80
    s_mov_b64 exec, -1
    v_min_f32 v6, v50, v66
    v_max_f32 v7, v50, v66
    v_cmp_le_f32 s[74:75], s72, v6
    v_cmp_ge_f32 vcc, s73, v7
    v_add_f32 v6, v48, v49
    s_and_b64 s[74:75], s[74:75], vcc
    v_add_f32 v40, v40, v41
    v_add_f32 v56, v56, v57
    v_add_f32 v42, v42, v43
    v_add_f32 v58, v58, v59
    v_add_f32 v44, v44, v45
    v_add_f32 v60, v60, v61
    v_add_f32 v46, v46, v47
    v_add_f32 v62, v62, v63
    v_add_f32 v40, v40, v42
    v_add_f32 v44, v44, v46
    v_add_f32 v56, v56, v58
    v_add_f32 v60, v60, v62
    v_add_f32 v40, v40, v44
    v_add_f32 v56, v56, v60
    v_add_f32 v6, v6, v40
    v_add_f32 v6, v6, v56
    v_cmp_class_f32 vcc, v6, s64
    s_and_b64 s[74:75], s[74:75], vcc
    s_or_b64 s[74:75], s[74:75], s[62:63]
    s_cmp_eq_u64 s[74:75], -1
    s_cbranch_scc0 L_fallback
    v_mov_b32 v4, s30
    v_lshlrev_b32 v5, 2, v1
    s_mov_b64 exec, 0xffff
    s_waitcnt vmcnt(0)
    buffer_store_dword v4, v5, s[52:55], s60 offen sc1
    s_mov_b64 exec, -1
    s_lshl_b32 s8, s2, 4
    s_add_u32 s8, s8, s3
    s_cmp_lg_u32 s8, 12
    s_cbranch_scc1 L_end_105
    s_mov_b32 s9, 0
    v_mov_b32 v4, s30
    s_mov_b64 exec, 1
    buffer_store_dword v4, off, s[52:55], s9 sc1
    s_mov_b64 exec, -1
L_end_105:
    s_endpgm
L_fallback:
    v_mov_b32 v4, s82
    s_mov_b32 s31, 524288
L_lspin_125:
    ds_read_b32 v5, v4 offset:80
    s_waitcnt lgkmcnt(0)
    v_readfirstlane_b32 s8, v5
    s_cmp_ge_u32 s8, 4
    s_cbranch_scc1 L_lsdone_126
    s_sleep 1
    s_sub_u32 s31, s31, 1
    s_cbranch_scc0 L_lspin_125
L_lsdone_126:
    s_lshl_b32 s8, s6, 11
    s_add_u32 s82, s8, 136192
    v_and_b32 v113, 31, v1
    v_lshlrev_b32 v113, 2, v113
    v_mov_b32 v77, 0
    v_add_u32 v114, s8, v114
    v_add_u32 v115, s8, v115
    v_add_u32 v116, s8, v116
    v_add_u32 v117, s8, v117
    v_mov_b32 v112, 0xff800000
    s_mov_b32 s77, 0
    v_mov_b32 v24, 0
    v_mov_b32 v40, 0
    v_mov_b32 v25, 0
    v_mov_b32 v41, 0
    v_mov_b32 v26, 0
    v_mov_b32 v42, 0
    v_mov_b32 v27, 0
    v_mov_b32 v43, 0
    v_mov_b32 v28, 0
    v_mov_b32 v44, 0
    v_mov_b32 v29, 0
    v_mov_b32 v45, 0
    v_mov_b32 v30, 0
    v_mov_b32 v46, 0
    v_mov_b32 v31, 0
    v_mov_b32 v47, 0
    v_mov_b32 v32, 0
    v_mov_b32 v48, 0
    v_mov_b32 v33, 0
    v_mov_b32 v49, 0
    v_mov_b32 v34, 0
    v_mov_b32 v50, 0
    v_mov_b32 v35, 0
    v_mov_b32 v51, 0
    v_mov_b32 v36, 0
    v_mov_b32 v52, 0
    v_mov_b32 v37, 0
    v_mov_b32 v53, 0
    v_mov_b32 v38, 0
    v_mov_b32 v54, 0
    v_mov_b32 v39, 0
    v_mov_b32 v55, 0
L_fbpass_127:
    s_mov_b32 s76, 0
L_fbtile_128:
    s_lshr_b32 s8, s76, 3
    s_mul_i32 s8, s8, 19456
    s_add_u32 s8, s8, s12
    s_and_b32 s9, s76, 7
    s_lshl_b32 s78, s9, 10
    s_add_u32 s78, s78, s8
    buffer_load_dwordx4 v[72:75], v119, s[52:55], s78 offen sc1
    s_lshl_b32 s78, s9, 7
    s_add_u32 s78, s78, s8
    s_add_u32 s78, s78, 8192
    buffer_load_dword v76, v113, s[52:55], s78 offen sc1
    s_mul_i32 s78, s9, 1280
    s_add_u32 s78, s78, s8
    s_add_u32 s78, s78, 9216
    s_mov_b32 m0, s82
    s_nop 0
    buffer_load_dwordx4 v119, s[52:55], s78 offen sc1 lds
    s_mov_b64 exec, 0xffff
    buffer_load_dwordx4 v119, s[52:55], s78 offen offset:1024 sc1 lds
    s_mov_b64 exec, -1
    s_waitcnt vmcnt(0)
    v_mfma_f32_32x32x8_bf16 v[8:23], v[76:77], v[96:97], v[24:39]
    v_mfma_f32_32x32x16_bf16 v[8:23], v[72:75], v[88:91], v[8:23]
    ds_read_b64_tr_b16 v[80:81], v114
    ds_read_b64_tr_b16 v[82:83], v115
    ds_read_b64_tr_b16 v[84:85], v116
    ds_read_b64_tr_b16 v[86:87], v117
    s_waitcnt lgkmcnt(0)
    s_nop 15
    s_cmp_lg_u32 s77, 0
    s_cbranch_scc1 L_fbp2_129
    v_max3_f32 v112, v8, v9, v112
    v_max3_f32 v112, v10, v11, v112
    v_max3_f32 v112, v12, v13, v112
    v_max3_f32 v112, v14, v15, v112
    v_max3_f32 v112, v16, v17, v112
    v_max3_f32 v112, v18, v19, v112
    v_max3_f32 v112, v20, v21, v112
    v_max3_f32 v112, v22, v23, v112
    s_branch L_fbnx_130
L_fbp2_129:
    v_exp_f32 v8, v8
    v_exp_f32 v9, v9
    v_exp_f32 v10, v10
    v_exp_f32 v11, v11
    v_exp_f32 v12, v12
    v_exp_f32 v13, v13
    v_exp_f32 v14, v14
    v_exp_f32 v15, v15
    v_exp_f32 v16, v16
    v_exp_f32 v17, v17
    v_exp_f32 v18, v18
    v_exp_f32 v19, v19
    v_exp_f32 v20, v20
    v_exp_f32 v21, v21
    v_exp_f32 v22, v22
    v_exp_f32 v23, v23
    s_nop 1
    v_smfmac_f32_32x32x32_bf16 v[40:55], v[80:83], v[8:15], v118
    v_smfmac_f32_32x32x32_bf16 v[40:55], v[84:87], v[16:23], v118
L_fbnx_130:
    s_add_u32 s76, s76, 1
    s_cmp_lt_u32 s76, 64
    s_cbranch_scc1 L_fbtile_128
    s_cmp_lg_u32 s77, 0
    s_cbranch_scc1 L_fbdone_131
    v_mov_b32 v6, v112
    s_nop 1
    v_permlane32_swap_b32 v112, v6
    s_nop 1
    v_max_f32 v112, v112, v6
    v_sub_f32 v24, 0, v112
    v_sub_f32 v25, 0, v112
    v_sub_f32 v26, 0, v112
    v_sub_f32 v27, 0, v112
    v_sub_f32 v28, 0, v112
    v_sub_f32 v29, 0, v112
    v_sub_f32 v30, 0, v112
    v_sub_f32 v31, 0, v112
    v_sub_f32 v32, 0, v112
    v_sub_f32 v33, 0, v112
    v_sub_f32 v34, 0, v112
    v_sub_f32 v35, 0, v112
    v_sub_f32 v36, 0, v112
    v_sub_f32 v37, 0, v112
    v_sub_f32 v38, 0, v112
    v_sub_f32 v39, 0, v112
    s_mov_b32 s77, 1
    s_branch L_fbpass_127
L_fbdone_131:
    s_nop 15
    v_mov_b32 v112, 0xff800000
    s_mov_b32 s77, 0
    v_mov_b32 v24, 0
    v_mov_b32 v56, 0
    v_mov_b32 v25, 0
    v_mov_b32 v57, 0
    v_mov_b32 v26, 0
    v_mov_b32 v58, 0
    v_mov_b32 v27, 0
    v_mov_b32 v59, 0
    v_mov_b32 v28, 0
    v_mov_b32 v60, 0
    v_mov_b32 v29, 0
    v_mov_b32 v61, 0
    v_mov_b32 v30, 0
    v_mov_b32 v62, 0
    v_mov_b32 v31, 0
    v_mov_b32 v63, 0
    v_mov_b32 v32, 0
    v_mov_b32 v64, 0
    v_mov_b32 v33, 0
    v_mov_b32 v65, 0
    v_mov_b32 v34, 0
    v_mov_b32 v66, 0
    v_mov_b32 v35, 0
    v_mov_b32 v67, 0
    v_mov_b32 v36, 0
    v_mov_b32 v68, 0
    v_mov_b32 v37, 0
    v_mov_b32 v69, 0
    v_mov_b32 v38, 0
    v_mov_b32 v70, 0
    v_mov_b32 v39, 0
    v_mov_b32 v71, 0
L_fbpass_132:
    s_mov_b32 s76, 0
L_fbtile_133:
    s_lshr_b32 s8, s76, 3
    s_mul_i32 s8, s8, 19456
    s_add_u32 s8, s8, s12
    s_and_b32 s9, s76, 7
    s_lshl_b32 s78, s9, 10
    s_add_u32 s78, s78, s8
    buffer_load_dwordx4 v[72:75], v119, s[52:55], s78 offen sc1
    s_lshl_b32 s78, s9, 7
    s_add_u32 s78, s78, s8
    s_add_u32 s78, s78, 8192
    buffer_load_dword v76, v113, s[52:55], s78 offen sc1
    s_mul_i32 s78, s9, 1280
    s_add_u32 s78, s78, s8
    s_add_u32 s78, s78, 9216
    s_mov_b32 m0, s82
    s_nop 0
    buffer_load_dwordx4 v119, s[52:55], s78 offen sc1 lds
    s_mov_b64 exec, 0xffff
    buffer_load_dwordx4 v119, s[52:55], s78 offen offset:1024 sc1 lds
    s_mov_b64 exec, -1
    s_waitcnt vmcnt(0)
    v_mfma_f32_32x32x8_bf16 v[8:23], v[76:77], v[104:105], v[24:39]
    v_mfma_f32_32x32x16_bf16 v[8:23], v[72:75], v[92:95], v[8:23]
    ds_read_b64_tr_b16 v[80:81], v114
    ds_read_b64_tr_b16 v[82:83], v115
    ds_read_b64_tr_b16 v[84:85], v116
    ds_read_b64_tr_b16 v[86:87], v117
    s_waitcnt lgkmcnt(0)
    s_nop 15
    s_cmp_lg_u32 s77, 0
    s_cbranch_scc1 L_fbp2_134
    v_max3_f32 v112, v8, v9, v112
    v_max3_f32 v112, v10, v11, v112
    v_max3_f32 v112, v12, v13, v112
    v_max3_f32 v112, v14, v15, v112
    v_max3_f32 v112, v16, v17, v112
    v_max3_f32 v112, v18, v19, v112
    v_max3_f32 v112, v20, v21, v112
    v_max3_f32 v112, v22, v23, v112
    s_branch L_fbnx_135
L_fbp2_134:
    v_exp_f32 v8, v8
    v_exp_f32 v9, v9
    v_exp_f32 v10, v10
    v_exp_f32 v11, v11
    v_exp_f32 v12, v12
    v_exp_f32 v13, v13
    v_exp_f32 v14, v14
    v_exp_f32 v15, v15
    v_exp_f32 v16, v16
    v_exp_f32 v17, v17
    v_exp_f32 v18, v18
    v_exp_f32 v19, v19
    v_exp_f32 v20, v20
    v_exp_f32 v21, v21
    v_exp_f32 v22, v22
    v_exp_f32 v23, v23
    s_nop 1
    v_smfmac_f32_32x32x32_bf16 v[56:71], v[80:83], v[8:15], v118
    v_smfmac_f32_32x32x32_bf16 v[56:71], v[84:87], v[16:23], v118
L_fbnx_135:
    s_add_u32 s76, s76, 1
    s_cmp_lt_u32 s76, 64
    s_cbranch_scc1 L_fbtile_133
    s_cmp_lg_u32 s77, 0
    s_cbranch_scc1 L_fbdone_136
    v_mov_b32 v6, v112
    s_nop 1
    v_permlane32_swap_b32 v112, v6
    s_nop 1
    v_max_f32 v112, v112, v6
    v_sub_f32 v24, 0, v112
    v_sub_f32 v25, 0, v112
    v_sub_f32 v26, 0, v112
    v_sub_f32 v27, 0, v112
    v_sub_f32 v28, 0, v112
    v_sub_f32 v29, 0, v112
    v_sub_f32 v30, 0, v112
    v_sub_f32 v31, 0, v112
    v_sub_f32 v32, 0, v112
    v_sub_f32 v33, 0, v112
    v_sub_f32 v34, 0, v112
    v_sub_f32 v35, 0, v112
    v_sub_f32 v36, 0, v112
    v_sub_f32 v37, 0, v112
    v_sub_f32 v38, 0, v112
    v_sub_f32 v39, 0, v112
    s_mov_b32 s77, 1
    s_branch L_fbpass_132
L_fbdone_136:
    s_nop 15
    s_mov_b32 s76, -1
    s_mov_b32 s77, 0
    s_mov_b32 s82, 163340
    s_mov_b64 s[62:63], -1
    v_permlane32_swap_b32 v50, v66
    v_permlane32_swap_b32 v48, v64
    v_permlane32_swap_b32 v49, v65
    s_nop 0
    v_mov_b32 v66, v50
    s_nop 1
    s_branch L_fin_103
L_end:
    s_endpgm
.section .rodata,"a"
.p2align 6
.amdhsa_kernel gated_mix__ssm_conv_s4d__mha_block__prompt_kernel
  .amdhsa_next_free_vgpr 128
  .amdhsa_next_free_sgpr 100
  .amdhsa_accum_offset 128
  .amdhsa_group_segment_fixed_size 0
  .amdhsa_kernarg_size 112
  .amdhsa_user_sgpr_count 2
  .amdhsa_user_sgpr_kernarg_segment_ptr 1
  .amdhsa_system_sgpr_workgroup_id_x 1
  .amdhsa_float_denorm_mode_32 3
.end_amdhsa_kernel
```
